```python
import torch

def _softmax(x, axis=-1):
    return torch.softmax(x, dim=axis)
def _gelu(x):
    return torch.nn.functional.gelu(x, approximate="tanh")
def _silu(x):
    return torch.nn.functional.silu(x)
def _sigmoid(x):
    return torch.sigmoid(x)
def _layernorm(x, axis=-1, eps=1e-5):
    m = x.mean(dim=axis, keepdim=True)
    v = x.var(dim=axis, keepdim=True, unbiased=False)
    return (x - m) / torch.sqrt(v + eps)
def _scatter_add(tgt, idx, src, axis=0):
    return tgt.clone().index_add_(axis, idx, src)
def _segment_sum(src, seg, n):
    out = torch.zeros((n,) + src.shape[1:], dtype=src.dtype)
    return out.index_add_(0, seg, src)
def _pad(x, pw):
    flat = tuple(v for pair in reversed(pw) for v in pair)
    return torch.nn.functional.pad(x, flat)

kernel_name = 'standalone__gqa_block_cached__near_ridge'

def setup_inputs():

    _w = (lambda a: (lambda t: t.to(torch.bfloat16) if t.is_floating_point() else t)(torch.as_tensor(a)))
    B, Sq, D = 8, 48, 1024
    Hq, Hkv, Sk, Dh = 32, 4, 1024, 128
    assert Hq % Hkv == 0, (Hq, Hkv)
    return {
        "x": _w((lambda *s: torch.randn(*s, dtype=torch.bfloat16) * 0.8)(B, Sq, D)),
        "k_cache": _w((lambda *s: torch.randn(*s, dtype=torch.bfloat16) * 0.8)(B, Hkv, Sk, Dh)),
        "v_cache": _w((lambda *s: torch.randn(*s, dtype=torch.bfloat16) * 0.05)(B, Hkv, Sk, Dh)),
        "wq": _w((lambda *s: torch.randn(*s, dtype=torch.bfloat16) * 0.8)(D, Hq * Dh) * (D ** -0.5)),
        "wo": _w((lambda *s: torch.randn(*s, dtype=torch.bfloat16) * 0.05)(Hq * Dh, D) * ((Hq * Dh) ** -0.5)),
    }

def reference(x, k_cache, v_cache, wq, wo):
    B, Sq, D = x.shape
    Hq, Dh = 32, 128
    Hkv = k_cache.shape[1]
    rep = Hq // Hkv
    q = (lambda x, *d: x.permute(*d))((x @ wq).reshape(B, Sq, Hq, Dh), 0, 2, 1, 3)
    k = (lambda x, n, axis: torch.repeat_interleave(x, n, dim=axis))(k_cache, rep, axis=1)
    v = (lambda x, n, axis: torch.repeat_interleave(x, n, dim=axis))(v_cache, rep, axis=1)
    scores = torch.einsum("bhqd,bhkd->bhqk", q, k) * (Dh ** -0.5)
    p = _softmax(scores, axis=-1)
    o = torch.einsum("bhqk,bhkd->bhqd", p, v)
    return (lambda x, *d: x.permute(*d))(o, 0, 2, 1, 3).reshape(B, Sq, Hq * Dh) @ wo
```

```asm
; @launch grid=(256,1,1) block=(256,1,1) lds=163840
.amdgcn_target "amdgcn-amd-amdhsa--gfx950"
.text
.globl standalone__gqa_block_cached__near_ridge_kernel
.p2align 12
.p2align 8
.type standalone__gqa_block_cached__near_ridge_kernel,@function
standalone__gqa_block_cached__near_ridge_kernel:
    s_cmp_ge_u32 s2, 256
    s_cbranch_scc1 L_end
    s_load_dwordx16 s[4:19], s[0:1], 0
    s_getpc_b64 s[92:93]
L_pc:
    s_mov_b32 s94, L_codeend-L_pc
    s_mov_b32 s95, 0x20000
    s_lshr_b32 s47, s2, 3
    v_lshlrev_b32 v5, 12, v0
    s_lshl_b32 s44, s47, 7
    v_add_u32 v5, s44, v5
    buffer_load_dword v255, v5, s[92:95], 0 offen
    v_lshrrev_b32 v1, 6, v0
    v_and_b32 v2, 63, v0
    v_readfirstlane_b32 s42, v1
    v_lshrrev_b32 v3, 4, v2
    v_and_b32 v4, 15, v2
    s_and_b32 s46, s2, 7
    s_lshr_b32 s48, s46, 1
    s_and_b32 s49, s47, 3
    s_and_b32 s50, s46, 1
    s_lshl_b32 s50, s50, 2
    s_add_u32 s50, s50, s49
    s_lshr_b32 s51, s47, 2
    s_lshl_b32 s52, s48, 3
    s_add_u32 s52, s52, s51
    s_mul_i32 s43, s42, 40960
    s_add_u32 s53, s50, s51
    s_and_b32 s53, s53, 7
    s_mov_b32 s54, 0x76532140
    s_cmp_eq_u32 s53, 1
    s_cselect_b32 s54, 0x76543210, s54
    s_cmp_eq_u32 s53, 2
    s_cselect_b32 s54, 0x76403521, s54
    s_cmp_eq_u32 s53, 3
    s_cselect_b32 s54, 0x76540321, s54
    s_cmp_eq_u32 s53, 4
    s_cselect_b32 s54, 0x75416032, s54
    s_cmp_eq_u32 s53, 5
    s_cselect_b32 s54, 0x76541032, s54
    s_cmp_eq_u32 s53, 6
    s_cselect_b32 s54, 0x65472103, s54
    s_cmp_eq_u32 s53, 7
    s_cselect_b32 s54, 0x76542103, s54
    s_lshl_b32 s44, s42, 2
    v_add_u32 v5, s44, v3
    v_xor_b32 v6, v4, v5
    v_lshlrev_b32 v6, 4, v6
    v_lshl_add_u32 v14, v5, 11, v6
    v_add_u32 v15, 31744, v14
    v_add_u32 v16, 63488, v14
    s_lshl_b32 s44, s42, 4
    v_add_u32 v5, s44, v3
    v_lshlrev_b32 v5, 13, v5
    v_lshlrev_b32 v6, 1, v3
    v_xor_b32 v6, v4, v6
    v_lshl_add_u32 v10, v6, 4, v5
    v_xor_b32 v6, 8, v6
    v_lshl_add_u32 v12, v6, 4, v5
    v_add_u32 v11, 31744, v10
    v_add_u32 v13, 95232, v12
    v_add_u32 v12, 63488, v12
    s_mul_i32 s44, s50, 98304
    s_lshl_b32 s45, s52, 8
    s_mov_b32 s22, 98304
    s_mov_b32 s23, 0x20000
    s_sub_u32 s26, 0x800000, s45
    s_mov_b32 s27, 0x20000
    s_waitcnt lgkmcnt(0)
    s_add_u32 s20, s4, s44
    s_addc_u32 s21, s5, 0
    s_add_u32 s24, s10, s45
    s_addc_u32 s25, s11, 0
    s_add_u32 m0, s43, 0
    s_bfe_u32 s57, s54, 0x40000
    s_lshl_b32 s57, s57, 8
    buffer_load_dwordx4 v14, s[20:23], s57 offen offset:0 lds
    buffer_load_dwordx4 v15, s[20:23], s57 offen offset:1024 lds
    buffer_load_dwordx4 v16, s[20:23], s57 offen offset:2048 lds
    s_add_u32 m0, s43, 4096
    s_bfe_u32 s57, s54, 0x40000
    s_lshl_b32 s57, s57, 20
    buffer_load_dwordx4 v10, s[24:27], s57 offen offset:0 lds
    buffer_load_dwordx4 v11, s[24:27], s57 offen offset:1024 lds
    buffer_load_dwordx4 v12, s[24:27], s57 offen offset:2048 lds
    buffer_load_dwordx4 v13, s[24:27], s57 offen offset:3072 lds
    s_lshr_b32 s44, s50, 1
    s_lshl_b32 s44, s44, 2
    s_add_u32 s59, s44, s48
    s_and_b32 s41, s50, 1
    s_lshl_b32 s41, s41, 3
    s_add_u32 s41, s41, s51
    s_lshl_b32 s44, s59, 12
    s_add_u32 s40, s44, 11534336
    s_mov_b32 s64, s18
    s_mov_b32 s65, s19
    s_mov_b32 s66, 0xC00000
    s_mov_b32 s67, 0x20000
    s_or_b32 s44, s41, s42
    s_lshl_b32 s44, s44, 24
    v_lshlrev_b32 v5, 4, v2
    v_lshlrev_b32 v6, 7, v2
    v_subrev_u32 v6, 2048, v6
    v_cmp_gt_u32 vcc, 32, v2
    v_lshlrev_b32 v8, 24, v2
    v_mov_b32 v200, 0
    v_cndmask_b32 v5, v6, v5, vcc
    v_cmp_gt_u32 vcc, 48, v2
    v_mov_b32 v201, 0
    v_mov_b32 v202, 0
    v_cndmask_b32 v5, v8, v5, vcc
    v_mov_b32 v203, 0
    v_add_u32 v192, s44, v5
    s_lshl_b32 s45, s59, 4
    s_add_u32 s44, s44, s45
    v_add_u32 v195, s44, v8
    v_mov_b32 v197, 1
    s_mov_b32 s4, s40
    s_mov_b32 s68, s16
    s_mov_b32 s69, s17
    s_mov_b32 s70, 256
    s_mov_b32 s71, 0x20000
    s_add_u32 m0, s43, 8192
    s_xor_b32 s57, s57, 524288
    buffer_load_dwordx4 v10, s[24:27], s57 offen offset:0 lds
    buffer_load_dwordx4 v11, s[24:27], s57 offen offset:1024 lds
    buffer_load_dwordx4 v12, s[24:27], s57 offen offset:2048 lds
    buffer_load_dwordx4 v13, s[24:27], s57 offen offset:3072 lds
    v_bfe_u32 v5, v2, 2, 3
    v_and_b32 v6, 3, v2
    v_lshlrev_b32 v6, 3, v6
    v_bfe_u32 v7, v2, 2, 2
    v_bfe_u32 v9, v2, 4, 1
    v_lshl_add_u32 v7, v9, 3, v7
    v_lshl_add_u32 v6, v7, 8, v6
    v_lshrrev_b32 v7, 5, v2
    v_mul_u32_u24 v7, 40960, v7
    v_add_u32 v6, v6, v7
    s_lshl_b32 s44, s42, 1
    s_add_u32 s45, s44, 0
    v_xor_b32 v7, s45, v5
    v_lshl_add_u32 v23, v7, 5, v6
    v_add_u32 v25, 81920, v23
    s_add_u32 s45, s44, 1
    v_xor_b32 v7, s45, v5
    v_lshl_add_u32 v24, v7, 5, v6
    v_add_u32 v26, 81920, v24
    v_lshrrev_b32 v5, 2, v4
    v_mul_u32_u24 v5, 40960, v5
    v_and_b32 v6, 3, v4
    v_lshl_add_u32 v5, v6, 8, v5
    v_lshlrev_b32 v7, 8, v4
    v_add_u32 v7, s43, v7
    v_or_b32 v6, 0, v3
    v_xor_b32 v6, v6, v4
    v_lshl_add_u32 v27, v6, 4, v5
    v_lshl_add_u32 v31, v6, 4, v7
    v_or_b32 v6, 4, v3
    v_xor_b32 v6, v6, v4
    v_lshl_add_u32 v28, v6, 4, v5
    v_lshl_add_u32 v32, v6, 4, v7
    v_or_b32 v6, 8, v3
    v_xor_b32 v6, v6, v4
    v_lshl_add_u32 v29, v6, 4, v5
    v_lshl_add_u32 v33, v6, 4, v7
    v_or_b32 v6, 12, v3
    v_xor_b32 v6, v6, v4
    v_lshl_add_u32 v30, v6, 4, v5
    v_lshl_add_u32 v34, v6, 4, v7
    s_mov_b64 exec, 0
    s_cmp_eq_u32 s42, 0
    s_cbranch_scc1 L_pad0
    s_cmp_eq_u32 s42, 1
    s_cbranch_scc1 L_pad1
    s_cmp_eq_u32 s42, 2
    s_cbranch_scc1 L_pad2
    s_branch L_pad3
L_warm_ret:
    s_mov_b64 exec, -1
    s_or_b32 s10, s41, s42
    s_cbranch_scc1 L_sk1
    buffer_store_dwordx4 v[200:203], v192, s[64:67], s4 offen sc1
L_sk1:
    s_add_u32 m0, s43, 12288
    s_bfe_u32 s57, s54, 0x40004
    s_lshl_b32 s57, s57, 8
    buffer_load_dwordx4 v14, s[20:23], s57 offen offset:0 lds
    buffer_load_dwordx4 v15, s[20:23], s57 offen offset:1024 lds
    buffer_load_dwordx4 v16, s[20:23], s57 offen offset:2048 lds
    s_add_u32 m0, s43, 16384
    s_bfe_u32 s57, s54, 0x40004
    s_lshl_b32 s57, s57, 20
    buffer_load_dwordx4 v10, s[24:27], s57 offen offset:0 lds
    buffer_load_dwordx4 v11, s[24:27], s57 offen offset:1024 lds
    buffer_load_dwordx4 v12, s[24:27], s57 offen offset:2048 lds
    buffer_load_dwordx4 v13, s[24:27], s57 offen offset:3072 lds
    s_add_u32 m0, s43, 20480
    s_xor_b32 s57, s57, 524288
    buffer_load_dwordx4 v10, s[24:27], s57 offen offset:0 lds
    s_waitcnt vmcnt(12)
    s_waitcnt lgkmcnt(0)
    s_barrier
    buffer_load_dwordx4 v11, s[24:27], s57 offen offset:1024 lds
    ds_read_b64_tr_b16 a[136:137], v23 offset:4096
    ds_read_b64_tr_b16 a[138:139], v23 offset:5120
    ds_read_b64_tr_b16 a[140:141], v24 offset:4096
    ds_read_b64_tr_b16 a[142:143], v24 offset:5120
    ds_read_b128 a[152:155], v27 offset:0
    ds_read_b128 a[156:159], v27 offset:1024
    ds_read_b128 a[160:163], v27 offset:2048
    ds_read_b64_tr_b16 a[144:145], v25 offset:4096
    ds_read_b64_tr_b16 a[146:147], v25 offset:5120
    ds_read_b64_tr_b16 a[148:149], v26 offset:4096
    ds_read_b64_tr_b16 a[150:151], v26 offset:5120
    ds_read_b128 a[164:167], v28 offset:0
    ds_read_b128 a[168:171], v28 offset:1024
    ds_read_b128 a[172:175], v28 offset:2048
    buffer_load_dwordx4 v12, s[24:27], s57 offen offset:2048 lds
    buffer_load_dwordx4 v13, s[24:27], s57 offen offset:3072 lds
    s_lshl_b32 s44, s50, 2
    s_add_u32 s44, s44, s48
    s_lshl_b32 s45, s44, 18
    s_add_u32 s28, s6, s45
    s_addc_u32 s29, s7, 0
    s_mov_b32 s30, 0x40000
    s_mov_b32 s31, 0x20000
    s_add_u32 s32, s8, s45
    s_addc_u32 s33, s9, 0
    s_mov_b32 s34, 0x40000
    s_mov_b32 s35, 0x20000
    s_mov_b32 s55, 0x76543120
    s_cmp_eq_u32 s51, 1
    s_cselect_b32 s55, 0x76543210, s55
    s_cmp_eq_u32 s51, 2
    s_cselect_b32 s55, 0x76542031, s55
    s_cmp_eq_u32 s51, 3
    s_cselect_b32 s55, 0x76532401, s55
    s_cmp_eq_u32 s51, 4
    s_cselect_b32 s55, 0x76432501, s55
    s_cmp_eq_u32 s51, 5
    s_cselect_b32 s55, 0x76543201, s55
    s_cmp_eq_u32 s51, 6
    s_cselect_b32 s55, 0x75436210, s55
    s_cmp_eq_u32 s51, 7
    s_cselect_b32 s55, 0x65437210, s55
    s_bfe_u32 s76, s55, 0x40000
    s_add_u32 m0, s43, 24576
    s_bfe_u32 s57, s54, 0x40008
    s_lshl_b32 s57, s57, 8
    buffer_load_dwordx4 v14, s[20:23], s57 offen offset:0 lds
    buffer_load_dwordx4 v15, s[20:23], s57 offen offset:1024 lds
    buffer_load_dwordx4 v16, s[20:23], s57 offen offset:2048 lds
    s_waitcnt vmcnt(14)
    s_waitcnt lgkmcnt(0)
    s_barrier
    s_add_u32 m0, s43, 28672
    s_bfe_u32 s57, s54, 0x40008
    s_lshl_b32 s57, s57, 20
    buffer_load_dwordx4 v10, s[24:27], s57 offen offset:0 lds
    v_mfma_f32_16x16x32_bf16 v[40:43], a[136:139], a[152:155], 0
    ds_read_b64_tr_b16 a[176:177], v23 offset:8192
    ds_read_b64_tr_b16 a[178:179], v23 offset:9216
    ds_read_b64_tr_b16 a[180:181], v24 offset:8192
    ds_read_b64_tr_b16 a[182:183], v24 offset:9216
    v_mfma_f32_16x16x32_bf16 v[40:43], a[144:147], a[164:167], v[40:43]
    buffer_load_dwordx4 v11, s[24:27], s57 offen offset:1024 lds
    ds_read_b128 a[192:195], v29 offset:0
    v_mfma_f32_16x16x32_bf16 v[52:55], a[140:143], a[152:155], 0
    ds_read_b128 a[196:199], v29 offset:1024
    v_mfma_f32_16x16x32_bf16 v[52:55], a[148:151], a[164:167], v[52:55]
    ds_read_b128 a[200:203], v29 offset:2048
    s_lshl_b32 s76, s76, 15
    s_lshr_b32 s49, 0x96, s51
    v_mfma_f32_16x16x32_bf16 v[44:47], a[136:139], a[156:159], 0
    buffer_load_dwordx4 v12, s[24:27], s57 offen offset:2048 lds
    ds_read_b64_tr_b16 a[184:185], v25 offset:8192
    ds_read_b64_tr_b16 a[186:187], v25 offset:9216
    ds_read_b64_tr_b16 a[188:189], v26 offset:8192
    ds_read_b64_tr_b16 a[190:191], v26 offset:9216
    s_and_b32 s49, s49, 1
    s_lshl_b32 s49, s49, 12
    v_mfma_f32_16x16x32_bf16 v[44:47], a[144:147], a[168:171], v[44:47]
    ds_read_b128 a[204:207], v30 offset:0
    s_add_u32 s76, s76, s49
    s_xor_b32 s77, s76, 4096
    v_mfma_f32_16x16x32_bf16 v[56:59], a[140:143], a[156:159], 0
    ds_read_b128 a[208:211], v30 offset:1024
    s_lshl_b32 s44, s42, 13
    v_lshlrev_b32 v5, 8, v3
    v_mfma_f32_16x16x32_bf16 v[56:59], a[148:151], a[168:171], v[56:59]
    buffer_load_dwordx4 v13, s[24:27], s57 offen offset:3072 lds
    ds_read_b128 a[212:215], v30 offset:2048
    v_add_u32 v5, s44, v5
    v_or_b32 v6, 0, v3
    v_mfma_f32_16x16x32_bf16 v[48:51], a[136:139], a[160:163], 0
    v_xor_b32 v6, v6, v4
    v_lshl_add_u32 v17, v6, 4, v5
    v_mfma_f32_16x16x32_bf16 v[48:51], a[144:147], a[172:175], v[48:51]
    v_or_b32 v6, 4, v3
    v_xor_b32 v6, v6, v4
    v_mfma_f32_16x16x32_bf16 v[60:63], a[140:143], a[160:163], 0
    s_add_u32 m0, s43, 32768
    s_xor_b32 s57, s57, 524288
    buffer_load_dwordx4 v10, s[24:27], s57 offen offset:0 lds
    v_lshl_add_u32 v18, v6, 4, v5
    v_or_b32 v6, 8, v3
    v_mfma_f32_16x16x32_bf16 v[60:63], a[148:151], a[172:175], v[60:63]
    v_xor_b32 v6, v6, v4
    v_lshl_add_u32 v19, v6, 4, v5
    s_waitcnt vmcnt(12)
    s_waitcnt lgkmcnt(0)
    s_barrier
    buffer_load_dwordx4 v11, s[24:27], s57 offen offset:1024 lds
    v_mfma_f32_16x16x32_bf16 v[40:43], a[176:179], a[192:195], v[40:43]
    ds_read_b64_tr_b16 a[136:137], v23 offset:16384
    ds_read_b64_tr_b16 a[138:139], v23 offset:17408
    ds_read_b64_tr_b16 a[140:141], v24 offset:16384
    ds_read_b64_tr_b16 a[142:143], v24 offset:17408
    v_mfma_f32_16x16x32_bf16 v[40:43], a[184:187], a[204:207], v[40:43]
    buffer_load_dwordx4 v12, s[24:27], s57 offen offset:2048 lds
    ds_read_b128 a[152:155], v27 offset:12288
    v_mfma_f32_16x16x32_bf16 v[52:55], a[180:183], a[192:195], v[52:55]
    ds_read_b128 a[156:159], v27 offset:13312
    v_mfma_f32_16x16x32_bf16 v[52:55], a[188:191], a[204:207], v[52:55]
    buffer_load_dwordx4 v13, s[24:27], s57 offen offset:3072 lds
    ds_read_b128 a[160:163], v27 offset:14336
    v_or_b32 v6, 12, v3
    v_xor_b32 v6, v6, v4
    v_mfma_f32_16x16x32_bf16 v[44:47], a[176:179], a[196:199], v[44:47]
    ds_read_b64_tr_b16 a[144:145], v25 offset:16384
    ds_read_b64_tr_b16 a[146:147], v25 offset:17408
    ds_read_b64_tr_b16 a[148:149], v26 offset:16384
    ds_read_b64_tr_b16 a[150:151], v26 offset:17408
    v_lshl_add_u32 v20, v6, 4, v5
    v_lshlrev_b32 v6, 1, v3
    v_mfma_f32_16x16x32_bf16 v[44:47], a[184:187], a[208:211], v[44:47]
    ds_read_b128 a[164:167], v28 offset:12288
    v_xor_b32 v6, v6, v4
    v_lshl_add_u32 v21, v6, 4, v5
    v_mfma_f32_16x16x32_bf16 v[56:59], a[180:183], a[196:199], v[56:59]
    s_or_b32 s10, s41, s42
    s_cbranch_scc1 L_sk2
    buffer_store_dword v197, v195, s[68:71], 0 offen sc1
L_sk2:
    ds_read_b128 a[168:171], v28 offset:13312
    v_xor_b32 v6, 8, v6
    v_lshl_add_u32 v22, v6, 4, v5
    v_mfma_f32_16x16x32_bf16 v[56:59], a[188:191], a[208:211], v[56:59]
    ds_read_b128 a[172:175], v28 offset:14336
    s_lshl_b32 s44, s50, 3
    s_add_u32 s44, s44, s51
    v_mfma_f32_16x16x32_bf16 v[48:51], a[176:179], a[200:203], v[48:51]
    s_add_u32 m0, s43, 36864
    s_bfe_u32 s57, s54, 0x4000c
    s_lshl_b32 s57, s57, 8
    buffer_load_dwordx4 v14, s[20:23], s57 offen offset:0 lds
    s_lshl_b32 s44, s44, 2
    s_add_u32 s45, s44, s42
    v_mfma_f32_16x16x32_bf16 v[48:51], a[184:187], a[212:215], v[48:51]
    s_add_u32 s44, s44, s48
    s_lshl_b32 s8, s45, 2
    v_mfma_f32_16x16x32_bf16 v[60:63], a[180:183], a[200:203], v[60:63]
    buffer_load_dwordx4 v15, s[20:23], s57 offen offset:1024 lds
    s_add_u32 s8, s8, s48
    s_mul_i32 s8, s8, 6144
    v_mfma_f32_16x16x32_bf16 v[60:63], a[188:191], a[212:215], v[60:63]
    s_add_u32 s8, s8, 4194304
    s_add_u32 s3, s8, 4096
    s_waitcnt vmcnt(13)
    s_waitcnt lgkmcnt(0)
    s_barrier
    buffer_load_dwordx4 v16, s[20:23], s57 offen offset:2048 lds
    v_mfma_f32_16x16x32_bf16 v[40:43], a[136:139], a[152:155], v[40:43]
    ds_read_b64_tr_b16 a[176:177], v23 offset:20480
    ds_read_b64_tr_b16 a[178:179], v23 offset:21504
    ds_read_b64_tr_b16 a[180:181], v24 offset:20480
    ds_read_b64_tr_b16 a[182:183], v24 offset:21504
    v_mfma_f32_16x16x32_bf16 v[40:43], a[144:147], a[164:167], v[40:43]
    s_add_u32 m0, s43, 4096
    s_bfe_u32 s57, s54, 0x4000c
    s_lshl_b32 s57, s57, 20
    buffer_load_dwordx4 v10, s[24:27], s57 offen offset:0 lds
    ds_read_b128 a[192:195], v29 offset:12288
    v_mfma_f32_16x16x32_bf16 v[52:55], a[140:143], a[152:155], v[52:55]
    ds_read_b128 a[196:199], v29 offset:13312
    v_mfma_f32_16x16x32_bf16 v[52:55], a[148:151], a[164:167], v[52:55]
    ds_read_b128 a[200:203], v29 offset:14336
    s_mul_i32 s9, s44, 24576
    s_add_u32 s9, s9, 4194304
    v_mfma_f32_16x16x32_bf16 v[44:47], a[136:139], a[156:159], v[44:47]
    buffer_load_dwordx4 v11, s[24:27], s57 offen offset:1024 lds
    ds_read_b64_tr_b16 a[184:185], v25 offset:20480
    ds_read_b64_tr_b16 a[186:187], v25 offset:21504
    ds_read_b64_tr_b16 a[188:189], v26 offset:20480
    ds_read_b64_tr_b16 a[190:191], v26 offset:21504
    s_cmp_eq_u32 s42, s48
    s_cselect_b32 s44, 0x1000000, 0
    v_lshl_add_u32 v199, v2, 4, s44
    v_mfma_f32_16x16x32_bf16 v[44:47], a[144:147], a[168:171], v[44:47]
    ds_read_b128 a[204:207], v30 offset:12288
    v_mov_b32 v204, -1
    v_mov_b32 v205, -1
    v_mfma_f32_16x16x32_bf16 v[56:59], a[140:143], a[156:159], v[56:59]
    ds_read_b128 a[208:211], v30 offset:13312
    v_mov_b32 v206, -1
    v_mov_b32 v207, -1
    v_mfma_f32_16x16x32_bf16 v[56:59], a[148:151], a[168:171], v[56:59]
    buffer_load_dwordx4 v12, s[24:27], s57 offen offset:2048 lds
    ds_read_b128 a[212:215], v30 offset:14336
    s_bfe_u32 s78, s55, 0x40004
    s_lshl_b32 s78, s78, 15
    v_mfma_f32_16x16x32_bf16 v[48:51], a[136:139], a[160:163], v[48:51]
    s_add_u32 s78, s78, s49
    s_xor_b32 s79, s78, 4096
    v_mfma_f32_16x16x32_bf16 v[48:51], a[144:147], a[172:175], v[48:51]
    s_bfe_u32 s80, s55, 0x40008
    s_lshl_b32 s80, s80, 15
    v_mfma_f32_16x16x32_bf16 v[60:63], a[140:143], a[160:163], v[60:63]
    buffer_load_dwordx4 v13, s[24:27], s57 offen offset:3072 lds
    s_add_u32 s80, s80, s49
    s_xor_b32 s81, s80, 4096
    v_mfma_f32_16x16x32_bf16 v[60:63], a[148:151], a[172:175], v[60:63]
    s_bfe_u32 s82, s55, 0x4000c
    s_lshl_b32 s82, s82, 15
    s_waitcnt vmcnt(11)
    s_waitcnt lgkmcnt(0)
    s_barrier
    s_add_u32 m0, s43, 8192
    s_xor_b32 s57, s57, 524288
    buffer_load_dwordx4 v10, s[24:27], s57 offen offset:0 lds
    v_mfma_f32_16x16x32_bf16 v[40:43], a[176:179], a[192:195], v[40:43]
    ds_read_b64_tr_b16 a[136:137], v23 offset:28672
    ds_read_b64_tr_b16 a[138:139], v23 offset:29696
    ds_read_b64_tr_b16 a[140:141], v24 offset:28672
    ds_read_b64_tr_b16 a[142:143], v24 offset:29696
    v_mfma_f32_16x16x32_bf16 v[40:43], a[184:187], a[204:207], v[40:43]
    buffer_load_dwordx4 v11, s[24:27], s57 offen offset:1024 lds
    ds_read_b128 a[152:155], v27 offset:24576
    v_mfma_f32_16x16x32_bf16 v[52:55], a[180:183], a[192:195], v[52:55]
    ds_read_b128 a[156:159], v27 offset:25600
    v_mfma_f32_16x16x32_bf16 v[52:55], a[188:191], a[204:207], v[52:55]
    buffer_load_dwordx4 v12, s[24:27], s57 offen offset:2048 lds
    ds_read_b128 a[160:163], v27 offset:26624
    s_add_u32 s82, s82, s49
    s_xor_b32 s83, s82, 4096
    v_mfma_f32_16x16x32_bf16 v[44:47], a[176:179], a[196:199], v[44:47]
    ds_read_b64_tr_b16 a[144:145], v25 offset:28672
    ds_read_b64_tr_b16 a[146:147], v25 offset:29696
    ds_read_b64_tr_b16 a[148:149], v26 offset:28672
    ds_read_b64_tr_b16 a[150:151], v26 offset:29696
    s_bfe_u32 s84, s55, 0x40010
    s_lshl_b32 s84, s84, 15
    v_mfma_f32_16x16x32_bf16 v[44:47], a[184:187], a[208:211], v[44:47]
    ds_read_b128 a[164:167], v28 offset:24576
    s_add_u32 s84, s84, s49
    s_xor_b32 s85, s84, 4096
    v_mfma_f32_16x16x32_bf16 v[56:59], a[180:183], a[196:199], v[56:59]
    buffer_load_dwordx4 v13, s[24:27], s57 offen offset:3072 lds
    ds_read_b128 a[168:171], v28 offset:25600
    s_bfe_u32 s86, s55, 0x40014
    s_lshl_b32 s86, s86, 15
    v_mfma_f32_16x16x32_bf16 v[56:59], a[188:191], a[208:211], v[56:59]
    ds_read_b128 a[172:175], v28 offset:26624
    s_add_u32 s86, s86, s49
    s_xor_b32 s87, s86, 4096
    v_mfma_f32_16x16x32_bf16 v[48:51], a[176:179], a[200:203], v[48:51]
    s_add_u32 m0, s43, 0
    s_bfe_u32 s57, s54, 0x40010
    s_lshl_b32 s57, s57, 8
    buffer_load_dwordx4 v14, s[20:23], s57 offen offset:0 lds
    s_bfe_u32 s88, s55, 0x40018
    s_lshl_b32 s88, s88, 15
    v_mfma_f32_16x16x32_bf16 v[48:51], a[184:187], a[212:215], v[48:51]
    s_add_u32 s88, s88, s49
    s_xor_b32 s89, s88, 4096
    v_mfma_f32_16x16x32_bf16 v[60:63], a[180:183], a[200:203], v[60:63]
    buffer_load_dwordx4 v15, s[20:23], s57 offen offset:1024 lds
    s_bfe_u32 s90, s55, 0x4001c
    s_lshl_b32 s90, s90, 15
    v_mfma_f32_16x16x32_bf16 v[60:63], a[188:191], a[212:215], v[60:63]
    s_add_u32 s90, s90, s49
    s_xor_b32 s91, s90, 4096
    s_waitcnt vmcnt(13)
    s_waitcnt lgkmcnt(0)
    s_barrier
    buffer_load_dwordx4 v16, s[20:23], s57 offen offset:2048 lds
    v_mfma_f32_16x16x32_bf16 v[40:43], a[136:139], a[152:155], v[40:43]
    ds_read_b64_tr_b16 a[176:177], v23 offset:32768
    ds_read_b64_tr_b16 a[178:179], v23 offset:33792
    ds_read_b64_tr_b16 a[180:181], v24 offset:32768
    ds_read_b64_tr_b16 a[182:183], v24 offset:33792
    v_mfma_f32_16x16x32_bf16 v[40:43], a[144:147], a[164:167], v[40:43]
    s_add_u32 m0, s43, 16384
    s_bfe_u32 s57, s54, 0x40010
    s_lshl_b32 s57, s57, 20
    buffer_load_dwordx4 v10, s[24:27], s57 offen offset:0 lds
    ds_read_b128 a[192:195], v29 offset:24576
    v_mfma_f32_16x16x32_bf16 v[52:55], a[140:143], a[152:155], v[52:55]
    ds_read_b128 a[196:199], v29 offset:25600
    v_mfma_f32_16x16x32_bf16 v[52:55], a[148:151], a[164:167], v[52:55]
    ds_read_b128 a[200:203], v29 offset:26624
    v_mov_b32 v5, 0x3f803f80
    v_accvgpr_write_b32 a132, v5
    v_mfma_f32_16x16x32_bf16 v[44:47], a[136:139], a[156:159], v[44:47]
    buffer_load_dwordx4 v11, s[24:27], s57 offen offset:1024 lds
    ds_read_b64_tr_b16 a[184:185], v25 offset:32768
    ds_read_b64_tr_b16 a[186:187], v25 offset:33792
    ds_read_b64_tr_b16 a[188:189], v26 offset:32768
    ds_read_b64_tr_b16 a[190:191], v26 offset:33792
    v_accvgpr_write_b32 a133, v5
    v_accvgpr_write_b32 a134, v5
    v_mfma_f32_16x16x32_bf16 v[44:47], a[144:147], a[168:171], v[44:47]
    ds_read_b128 a[204:207], v30 offset:24576
    v_accvgpr_write_b32 a135, v5
    v_lshrrev_b32 v5, 5, v2
    v_mfma_f32_16x16x32_bf16 v[56:59], a[140:143], a[156:159], v[56:59]
    ds_read_b128 a[208:211], v30 offset:25600
    v_lshl_add_u32 v5, v5, 4, v4
    v_lshlrev_b32 v5, 4, v5
    v_mfma_f32_16x16x32_bf16 v[56:59], a[148:151], a[168:171], v[56:59]
L_pad0:
    s_cbranch_execz L_pad4
    s_nop 0
    buffer_load_dwordx4 v12, s[24:27], s57 offen offset:2048 lds
    ds_read_b128 a[212:215], v30 offset:26624
    v_bfe_u32 v6, v2, 4, 1
    v_lshl_add_u32 v5, v6, 3, v5
    v_mfma_f32_16x16x32_bf16 v[48:51], a[136:139], a[160:163], v[48:51]
    v_add_u32 v35, s43, v5
    v_lshlrev_b32 v36, 4, v2
    v_mfma_f32_16x16x32_bf16 v[48:51], a[144:147], a[172:175], v[48:51]
    v_add_u32 v37, 40960, v36
    v_add_u32 v38, 81920, v36
    v_mfma_f32_16x16x32_bf16 v[60:63], a[140:143], a[160:163], v[60:63]
    buffer_load_dwordx4 v13, s[24:27], s57 offen offset:3072 lds
    v_add_u32 v39, 122880, v36
    s_lshl_b32 s44, s42, 13
    v_mfma_f32_16x16x32_bf16 v[60:63], a[148:151], a[172:175], v[60:63]
    v_add_u32 v9, s44, v36
    s_mov_b32 s58, 1040356334
    s_waitcnt vmcnt(11)
    s_waitcnt lgkmcnt(0)
    s_barrier
    s_add_u32 m0, s43, 20480
    s_xor_b32 s57, s57, 524288
    buffer_load_dwordx4 v10, s[24:27], s57 offen offset:0 lds
    v_mfma_f32_16x16x32_bf16 v[40:43], a[176:179], a[192:195], v[40:43]
    ds_read_b64_tr_b16 a[136:137], v23 offset:4096
    ds_read_b64_tr_b16 a[138:139], v23 offset:5120
    ds_read_b64_tr_b16 a[140:141], v24 offset:4096
    ds_read_b64_tr_b16 a[142:143], v24 offset:5120
    v_mfma_f32_16x16x32_bf16 v[40:43], a[184:187], a[204:207], v[40:43]
    buffer_load_dwordx4 v11, s[24:27], s57 offen offset:1024 lds
    ds_read_b128 a[152:155], v27 offset:36864
    v_mfma_f32_16x16x32_bf16 v[52:55], a[180:183], a[192:195], v[52:55]
    ds_read_b128 a[156:159], v27 offset:37888
    v_mfma_f32_16x16x32_bf16 v[52:55], a[188:191], a[204:207], v[52:55]
    buffer_load_dwordx4 v12, s[24:27], s57 offen offset:2048 lds
    ds_read_b128 a[160:163], v27 offset:38912
    s_lshl_b32 s40, s51, 10
    s_add_u32 s40, s40, s44
    v_mfma_f32_16x16x32_bf16 v[44:47], a[176:179], a[196:199], v[44:47]
    ds_read_b64_tr_b16 a[144:145], v25 offset:4096
    ds_read_b64_tr_b16 a[146:147], v25 offset:5120
    ds_read_b64_tr_b16 a[148:149], v26 offset:4096
    ds_read_b64_tr_b16 a[150:151], v26 offset:5120
    s_and_b32 s44, s50, 1
    s_mul_i32 s44, s44, 393216
    v_mfma_f32_16x16x32_bf16 v[44:47], a[184:187], a[208:211], v[44:47]
    ds_read_b128 a[164:167], v28 offset:36864
    s_add_u32 s40, s40, s44
    s_and_b32 s16, s50, 6
    v_mfma_f32_16x16x32_bf16 v[56:59], a[180:183], a[196:199], v[56:59]
    buffer_load_dwordx4 v13, s[24:27], s57 offen offset:3072 lds
    ds_read_b128 a[168:171], v28 offset:37888
    s_lshl_b32 s17, s51, 8
    s_and_b32 s44, s50, 1
    v_mfma_f32_16x16x32_bf16 v[56:59], a[188:191], a[208:211], v[56:59]
    ds_read_b128 a[172:175], v28 offset:38912
    s_lshl_b32 s44, s44, 7
    s_add_u32 s17, s17, s44
    v_mfma_f32_16x16x32_bf16 v[48:51], a[176:179], a[200:203], v[48:51]
    s_add_u32 m0, s43, 12288
    s_bfe_u32 s57, s54, 0x40014
    s_lshl_b32 s57, s57, 8
    buffer_load_dwordx4 v14, s[20:23], s57 offen offset:0 lds
    v_mov_b32 v220, 0xff800000
    v_mov_b32 v221, 0xff800000
    v_mfma_f32_16x16x32_bf16 v[48:51], a[184:187], a[212:215], v[48:51]
    v_mov_b32 v222, 0xff800000
    s_mov_b32 s53, 0
    v_mfma_f32_16x16x32_bf16 v[60:63], a[180:183], a[200:203], v[60:63]
    buffer_load_dwordx4 v15, s[20:23], s57 offen offset:1024 lds
    s_mov_b32 s52, 0x49800000
    s_lshl_b32 s44, s16, 2
    v_mfma_f32_16x16x32_bf16 v[60:63], a[188:191], a[212:215], v[60:63]
    s_add_u32 s44, s44, s48
    s_mul_i32 s44, s44, 98304
    s_waitcnt vmcnt(13)
    s_waitcnt lgkmcnt(0)
    s_barrier
    buffer_load_dwordx4 v16, s[20:23], s57 offen offset:2048 lds
    v_mfma_f32_16x16x32_bf16 v[40:43], a[136:139], a[152:155], v[40:43]
    ds_read_b64_tr_b16 a[176:177], v23 offset:8192
    ds_read_b64_tr_b16 a[178:179], v23 offset:9216
    ds_read_b64_tr_b16 a[180:181], v24 offset:8192
    ds_read_b64_tr_b16 a[182:183], v24 offset:9216
    v_mfma_f32_16x16x32_bf16 v[40:43], a[144:147], a[164:167], v[40:43]
    s_add_u32 m0, s43, 28672
    s_bfe_u32 s57, s54, 0x40014
    s_lshl_b32 s57, s57, 20
    buffer_load_dwordx4 v10, s[24:27], s57 offen offset:0 lds
    ds_read_b128 a[192:195], v29 offset:36864
    v_mfma_f32_16x16x32_bf16 v[52:55], a[140:143], a[152:155], v[52:55]
    ds_read_b128 a[196:199], v29 offset:37888
    v_mfma_f32_16x16x32_bf16 v[52:55], a[148:151], a[164:167], v[52:55]
    ds_read_b128 a[200:203], v29 offset:38912
    s_add_u32 s44, s44, 0
    s_add_u32 s36, s18, s44
    s_addc_u32 s37, s19, 0
    v_mfma_f32_16x16x32_bf16 v[44:47], a[136:139], a[156:159], v[44:47]
    buffer_load_dwordx4 v11, s[24:27], s57 offen offset:1024 lds
    ds_read_b64_tr_b16 a[184:185], v25 offset:8192
    ds_read_b64_tr_b16 a[186:187], v25 offset:9216
    ds_read_b64_tr_b16 a[188:189], v26 offset:8192
    ds_read_b64_tr_b16 a[190:191], v26 offset:9216
    s_mov_b32 s38, 491520
    s_mov_b32 s39, 0x20000
    v_mfma_f32_16x16x32_bf16 v[44:47], a[144:147], a[168:171], v[44:47]
    ds_read_b128 a[204:207], v30 offset:36864
    s_mov_b32 s72, s14
    s_mov_b32 s73, s15
    v_mfma_f32_16x16x32_bf16 v[56:59], a[140:143], a[156:159], v[56:59]
    ds_read_b128 a[208:211], v30 offset:37888
    s_mov_b32 s74, 786432
    s_mov_b32 s75, 0x20000
    v_mfma_f32_16x16x32_bf16 v[56:59], a[148:151], a[168:171], v[56:59]
    buffer_load_dwordx4 v12, s[24:27], s57 offen offset:2048 lds
    ds_read_b128 a[212:215], v30 offset:38912
    s_getreg_b32 s11, hwreg(HW_REG_XCC_ID, 0, 4)
    s_add_u32 s11, s11, 16
    v_mfma_f32_16x16x32_bf16 v[48:51], a[136:139], a[160:163], v[48:51]
    v_mov_b32 v196, s11
    s_lshl_b32 s44, s42, 24
    v_mfma_f32_16x16x32_bf16 v[48:51], a[144:147], a[172:175], v[48:51]
    s_lshl_b32 s45, s41, 2
    s_add_u32 s44, s44, s45
    v_mfma_f32_16x16x32_bf16 v[60:63], a[140:143], a[160:163], v[60:63]
    buffer_load_dwordx4 v13, s[24:27], s57 offen offset:3072 lds
    v_add_u32 v194, s44, v8
    v_lshlrev_b32 v1, 4, v4
    v_mfma_f32_16x16x32_bf16 v[60:63], a[148:151], a[172:175], v[60:63]
    s_lshl_b32 s5, s42, 6
    s_add_u32 s5, s5, s4
    s_waitcnt vmcnt(11)
    s_waitcnt lgkmcnt(0)
    s_barrier
    s_add_u32 m0, s43, 32768
    s_xor_b32 s57, s57, 524288
    buffer_load_dwordx4 v10, s[24:27], s57 offen offset:0 lds
    v_mfma_f32_16x16x32_bf16 v[40:43], a[176:179], a[192:195], v[40:43]
    ds_read_b64_tr_b16 a[136:137], v23 offset:16384
    ds_read_b64_tr_b16 a[138:139], v23 offset:17408
    ds_read_b64_tr_b16 a[140:141], v24 offset:16384
    ds_read_b64_tr_b16 a[142:143], v24 offset:17408
    v_mfma_f32_16x16x32_bf16 v[40:43], a[184:187], a[204:207], v[40:43]
    buffer_load_dwordx4 v11, s[24:27], s57 offen offset:1024 lds
    ds_read_b128 a[152:155], v27 offset:0
    v_mfma_f32_16x16x32_bf16 v[52:55], a[180:183], a[192:195], v[52:55]
    ds_read_b128 a[156:159], v27 offset:1024
    v_mfma_f32_16x16x32_bf16 v[52:55], a[188:191], a[204:207], v[52:55]
    buffer_load_dwordx4 v12, s[24:27], s57 offen offset:2048 lds
    ds_read_b128 a[160:163], v27 offset:2048
    s_add_u32 s6, s5, s45
    s_and_b32 s44, s59, 12
    v_mfma_f32_16x16x32_bf16 v[44:47], a[176:179], a[196:199], v[44:47]
    ds_read_b64_tr_b16 a[144:145], v25 offset:16384
    ds_read_b64_tr_b16 a[146:147], v25 offset:17408
    ds_read_b64_tr_b16 a[148:149], v26 offset:16384
    ds_read_b64_tr_b16 a[150:151], v26 offset:17408
    s_add_u32 s44, s44, s42
    s_lshl_b32 s44, s44, 12
    v_mfma_f32_16x16x32_bf16 v[44:47], a[184:187], a[208:211], v[44:47]
    ds_read_b128 a[164:167], v28 offset:0
    s_lshl_b32 s45, s41, 7
    s_add_u32 s44, s44, s45
    v_mfma_f32_16x16x32_bf16 v[56:59], a[180:183], a[196:199], v[56:59]
    buffer_load_dwordx4 v13, s[24:27], s57 offen offset:3072 lds
    ds_read_b128 a[168:171], v28 offset:1024
    s_lshl_b32 s45, s48, 2
    s_add_u32 s44, s44, s45
    v_mfma_f32_16x16x32_bf16 v[56:59], a[188:191], a[208:211], v[56:59]
    ds_read_b128 a[172:175], v28 offset:2048
    s_add_u32 s7, s44, 11536384
    v_bfe_u32 v5, v2, 2, 3
    v_mfma_f32_16x16x32_bf16 v[48:51], a[176:179], a[200:203], v[48:51]
    s_add_u32 m0, s43, 24576
    s_bfe_u32 s57, s54, 0x40018
    s_lshl_b32 s57, s57, 8
    buffer_load_dwordx4 v14, s[20:23], s57 offen offset:0 lds
    v_and_b32 v6, 3, v2
    v_lshlrev_b32 v6, 3, v6
    v_mfma_f32_16x16x32_bf16 v[48:51], a[184:187], a[212:215], v[48:51]
    v_lshrrev_b32 v7, 2, v2
    v_lshl_add_u32 v6, v7, 8, v6
    v_mfma_f32_16x16x32_bf16 v[60:63], a[180:183], a[200:203], v[60:63]
    buffer_load_dwordx4 v15, s[20:23], s57 offen offset:1024 lds
    v_add_u32 v6, s43, v6
    s_lshl_b32 s44, s42, 1
    v_mfma_f32_16x16x32_bf16 v[60:63], a[188:191], a[212:215], v[60:63]
    s_add_u32 s45, s44, 0
    s_and_b32 s45, s45, 7
    s_waitcnt vmcnt(13)
    s_waitcnt lgkmcnt(0)
    s_barrier
    buffer_load_dwordx4 v16, s[20:23], s57 offen offset:2048 lds
    v_mfma_f32_16x16x32_bf16 v[40:43], a[136:139], a[152:155], v[40:43]
    ds_read_b64_tr_b16 a[176:177], v23 offset:20480
    ds_read_b64_tr_b16 a[178:179], v23 offset:21504
    ds_read_b64_tr_b16 a[180:181], v24 offset:20480
    ds_read_b64_tr_b16 a[182:183], v24 offset:21504
    v_mfma_f32_16x16x32_bf16 v[40:43], a[144:147], a[164:167], v[40:43]
    s_add_u32 m0, s43, 4096
    s_bfe_u32 s57, s54, 0x40018
    s_lshl_b32 s57, s57, 20
    buffer_load_dwordx4 v10, s[24:27], s57 offen offset:0 lds
    ds_read_b128 a[192:195], v29 offset:0
    v_mfma_f32_16x16x32_bf16 v[52:55], a[140:143], a[152:155], v[52:55]
    ds_read_b128 a[196:199], v29 offset:1024
    v_mfma_f32_16x16x32_bf16 v[52:55], a[148:151], a[164:167], v[52:55]
    ds_read_b128 a[200:203], v29 offset:2048
    v_xor_b32 v7, s45, v5
    v_lshl_add_u32 v160, v7, 5, v6
    v_mfma_f32_16x16x32_bf16 v[44:47], a[136:139], a[156:159], v[44:47]
    buffer_load_dwordx4 v11, s[24:27], s57 offen offset:1024 lds
    ds_read_b64_tr_b16 a[184:185], v25 offset:20480
    ds_read_b64_tr_b16 a[186:187], v25 offset:21504
    ds_read_b64_tr_b16 a[188:189], v26 offset:20480
    ds_read_b64_tr_b16 a[190:191], v26 offset:21504
    s_add_u32 s45, s44, 1
    s_and_b32 s45, s45, 7
    v_mfma_f32_16x16x32_bf16 v[44:47], a[144:147], a[168:171], v[44:47]
    ds_read_b128 a[204:207], v30 offset:0
    v_xor_b32 v7, s45, v5
    v_lshl_add_u32 v161, v7, 5, v6
    v_mfma_f32_16x16x32_bf16 v[56:59], a[140:143], a[156:159], v[56:59]
    ds_read_b128 a[208:211], v30 offset:1024
    s_add_u32 s45, s44, 2
    s_and_b32 s45, s45, 7
    v_mfma_f32_16x16x32_bf16 v[56:59], a[148:151], a[168:171], v[56:59]
    buffer_load_dwordx4 v12, s[24:27], s57 offen offset:2048 lds
    ds_read_b128 a[212:215], v30 offset:2048
    v_xor_b32 v7, s45, v5
    v_lshl_add_u32 v162, v7, 5, v6
    v_mfma_f32_16x16x32_bf16 v[48:51], a[136:139], a[160:163], v[48:51]
    s_add_u32 s45, s44, 3
    s_and_b32 s45, s45, 7
    v_mfma_f32_16x16x32_bf16 v[48:51], a[144:147], a[172:175], v[48:51]
    v_xor_b32 v7, s45, v5
    v_lshl_add_u32 v163, v7, 5, v6
    v_mfma_f32_16x16x32_bf16 v[60:63], a[140:143], a[160:163], v[60:63]
    buffer_load_dwordx4 v13, s[24:27], s57 offen offset:3072 lds
    s_add_u32 s45, s44, 4
    s_and_b32 s45, s45, 7
    v_mfma_f32_16x16x32_bf16 v[60:63], a[148:151], a[172:175], v[60:63]
    v_xor_b32 v7, s45, v5
    v_lshl_add_u32 v164, v7, 5, v6
    s_waitcnt vmcnt(11)
    s_waitcnt lgkmcnt(0)
    s_barrier
    s_add_u32 m0, s43, 8192
    s_xor_b32 s57, s57, 524288
    buffer_load_dwordx4 v10, s[24:27], s57 offen offset:0 lds
    v_mfma_f32_16x16x32_bf16 v[40:43], a[176:179], a[192:195], v[40:43]
    ds_read_b64_tr_b16 a[136:137], v23 offset:28672
    ds_read_b64_tr_b16 a[138:139], v23 offset:29696
    ds_read_b64_tr_b16 a[140:141], v24 offset:28672
    ds_read_b64_tr_b16 a[142:143], v24 offset:29696
    v_mfma_f32_16x16x32_bf16 v[40:43], a[184:187], a[204:207], v[40:43]
    buffer_load_dwordx4 v11, s[24:27], s57 offen offset:1024 lds
    ds_read_b128 a[152:155], v27 offset:12288
    v_mfma_f32_16x16x32_bf16 v[52:55], a[180:183], a[192:195], v[52:55]
    ds_read_b128 a[156:159], v27 offset:13312
    v_mfma_f32_16x16x32_bf16 v[52:55], a[188:191], a[204:207], v[52:55]
    buffer_load_dwordx4 v12, s[24:27], s57 offen offset:2048 lds
    ds_read_b128 a[160:163], v27 offset:14336
    s_add_u32 s45, s44, 5
    s_and_b32 s45, s45, 7
    v_mfma_f32_16x16x32_bf16 v[44:47], a[176:179], a[196:199], v[44:47]
    ds_read_b64_tr_b16 a[144:145], v25 offset:28672
    ds_read_b64_tr_b16 a[146:147], v25 offset:29696
    ds_read_b64_tr_b16 a[148:149], v26 offset:28672
    ds_read_b64_tr_b16 a[150:151], v26 offset:29696
    v_xor_b32 v7, s45, v5
    v_lshl_add_u32 v165, v7, 5, v6
    v_mfma_f32_16x16x32_bf16 v[44:47], a[184:187], a[208:211], v[44:47]
    ds_read_b128 a[164:167], v28 offset:12288
    s_add_u32 s45, s44, 6
    s_and_b32 s45, s45, 7
    v_mfma_f32_16x16x32_bf16 v[56:59], a[180:183], a[196:199], v[56:59]
    buffer_load_dwordx4 v13, s[24:27], s57 offen offset:3072 lds
    ds_read_b128 a[168:171], v28 offset:13312
    v_xor_b32 v7, s45, v5
    v_lshl_add_u32 v166, v7, 5, v6
    v_mfma_f32_16x16x32_bf16 v[56:59], a[188:191], a[208:211], v[56:59]
    ds_read_b128 a[172:175], v28 offset:14336
    s_add_u32 s45, s44, 7
    s_and_b32 s45, s45, 7
    v_mfma_f32_16x16x32_bf16 v[48:51], a[176:179], a[200:203], v[48:51]
    s_add_u32 m0, s43, 36864
    s_bfe_u32 s57, s54, 0x4001c
    s_lshl_b32 s57, s57, 8
    buffer_load_dwordx4 v14, s[20:23], s57 offen offset:0 lds
    v_xor_b32 v7, s45, v5
    v_lshl_add_u32 v167, v7, 5, v6
    v_mfma_f32_16x16x32_bf16 v[48:51], a[184:187], a[212:215], v[48:51]
    s_and_b32 s44, s51, 3
    s_mul_i32 s44, s44, 1
    v_mfma_f32_16x16x32_bf16 v[60:63], a[180:183], a[200:203], v[60:63]
    buffer_load_dwordx4 v15, s[20:23], s57 offen offset:1024 lds
    s_lshr_b32 s45, s50, 1
    s_and_b32 s45, s45, 2
    v_mfma_f32_16x16x32_bf16 v[60:63], a[188:191], a[212:215], v[60:63]
    s_add_u32 s44, s44, s45
    s_and_b32 s44, s44, 3
    s_waitcnt vmcnt(13)
    s_waitcnt lgkmcnt(0)
    s_barrier
    buffer_load_dwordx4 v16, s[20:23], s57 offen offset:2048 lds
    v_mfma_f32_16x16x32_bf16 v[40:43], a[136:139], a[152:155], v[40:43]
    ds_read_b64_tr_b16 a[176:177], v23 offset:32768
    ds_read_b64_tr_b16 a[178:179], v23 offset:33792
    ds_read_b64_tr_b16 a[180:181], v24 offset:32768
    ds_read_b64_tr_b16 a[182:183], v24 offset:33792
    v_mfma_f32_16x16x32_bf16 v[40:43], a[144:147], a[164:167], v[40:43]
    s_add_u32 m0, s43, 16384
    s_bfe_u32 s57, s54, 0x4001c
    s_lshl_b32 s57, s57, 20
    buffer_load_dwordx4 v10, s[24:27], s57 offen offset:0 lds
    ds_read_b128 a[192:195], v29 offset:12288
    v_mfma_f32_16x16x32_bf16 v[52:55], a[140:143], a[152:155], v[52:55]
    ds_read_b128 a[196:199], v29 offset:13312
    v_mfma_f32_16x16x32_bf16 v[52:55], a[148:151], a[164:167], v[52:55]
    ds_read_b128 a[200:203], v29 offset:14336
    s_lshl_b32 s44, s44, 3
    s_mov_b32 s62, 0x76543210
    v_mfma_f32_16x16x32_bf16 v[44:47], a[136:139], a[156:159], v[44:47]
    buffer_load_dwordx4 v11, s[24:27], s57 offen offset:1024 lds
    ds_read_b64_tr_b16 a[184:185], v25 offset:32768
    ds_read_b64_tr_b16 a[186:187], v25 offset:33792
    ds_read_b64_tr_b16 a[188:189], v26 offset:32768
    ds_read_b64_tr_b16 a[190:191], v26 offset:33792
    s_mov_b32 s63, 0x76543210
    s_lshr_b64 s[62:63], s[62:63], s44
    v_mfma_f32_16x16x32_bf16 v[44:47], a[144:147], a[168:171], v[44:47]
    ds_read_b128 a[204:207], v30 offset:12288
    s_mov_b32 s56, s62
    v_lshrrev_b32 v5, 3, v2
    v_mfma_f32_16x16x32_bf16 v[56:59], a[140:143], a[156:159], v[56:59]
    ds_read_b128 a[208:211], v30 offset:13312
    v_and_b32 v6, 6, v5
    v_and_b32 v7, 7, v2
    v_mfma_f32_16x16x32_bf16 v[56:59], a[148:151], a[168:171], v[56:59]
    buffer_load_dwordx4 v12, s[24:27], s57 offen offset:2048 lds
    ds_read_b128 a[212:215], v30 offset:14336
    v_xor_b32 v6, v6, v7
    s_lshl_b32 s44, s42, 5
    v_mfma_f32_16x16x32_bf16 v[48:51], a[136:139], a[160:163], v[48:51]
    v_add_u32 v5, s44, v5
    v_lshlrev_b32 v5, 11, v5
    v_mfma_f32_16x16x32_bf16 v[48:51], a[144:147], a[172:175], v[48:51]
    v_lshl_add_u32 v168, v6, 4, v5
    v_add_u32 v169, 15360, v168
    v_mfma_f32_16x16x32_bf16 v[60:63], a[140:143], a[160:163], v[60:63]
    buffer_load_dwordx4 v13, s[24:27], s57 offen offset:3072 lds
    v_add_u32 v170, 30720, v168
    v_add_u32 v171, 46080, v168
    v_mfma_f32_16x16x32_bf16 v[60:63], a[148:151], a[172:175], v[60:63]
    v_lshrrev_b32 v5, 2, v2
    v_and_b32 v6, 3, v2
    s_waitcnt vmcnt(11)
    s_waitcnt lgkmcnt(0)
    s_barrier
    s_add_u32 m0, s43, 20480
    s_xor_b32 s57, s57, 524288
    buffer_load_dwordx4 v10, s[24:27], s57 offen offset:0 lds
    v_mfma_f32_16x16x32_bf16 v[40:43], a[176:179], a[192:195], v[40:43]
    ds_read_b64_tr_b16 a[136:137], v23 offset:4096
    ds_read_b64_tr_b16 a[138:139], v23 offset:5120
    ds_read_b64_tr_b16 a[140:141], v24 offset:4096
    ds_read_b64_tr_b16 a[142:143], v24 offset:5120
    v_mfma_f32_16x16x32_bf16 v[40:43], a[184:187], a[204:207], v[40:43]
    buffer_load_dwordx4 v11, s[24:27], s57 offen offset:1024 lds
    ds_read_b128 a[152:155], v27 offset:24576
    v_mfma_f32_16x16x32_bf16 v[52:55], a[180:183], a[192:195], v[52:55]
    ds_read_b128 a[156:159], v27 offset:25600
    v_mfma_f32_16x16x32_bf16 v[52:55], a[188:191], a[204:207], v[52:55]
    buffer_load_dwordx4 v12, s[24:27], s57 offen offset:2048 lds
    ds_read_b128 a[160:163], v27 offset:26624
    v_lshlrev_b32 v6, 3, v6
    v_lshl_add_u32 v5, v5, 7, v6
    v_mfma_f32_16x16x32_bf16 v[44:47], a[176:179], a[196:199], v[44:47]
    ds_read_b64_tr_b16 a[144:145], v25 offset:4096
    ds_read_b64_tr_b16 a[146:147], v25 offset:5120
    ds_read_b64_tr_b16 a[148:149], v26 offset:4096
    ds_read_b64_tr_b16 a[150:151], v26 offset:5120
    v_bfe_u32 v6, v2, 3, 2
    s_and_b32 s44, s42, 1
    v_mfma_f32_16x16x32_bf16 v[44:47], a[184:187], a[208:211], v[44:47]
    ds_read_b128 a[164:167], v28 offset:24576
    s_lshl_b32 s44, s44, 1
    v_xor_b32 v6, s44, v6
    v_mfma_f32_16x16x32_bf16 v[56:59], a[180:183], a[196:199], v[56:59]
    buffer_load_dwordx4 v13, s[24:27], s57 offen offset:3072 lds
    ds_read_b128 a[168:171], v28 offset:25600
    v_lshl_add_u32 v224, v6, 5, v5
    v_xor_b32 v225, 32, v224
    v_mfma_f32_16x16x32_bf16 v[56:59], a[188:191], a[208:211], v[56:59]
    ds_read_b128 a[172:175], v28 offset:26624
    s_mul_i32 s44, s44, 40960
    v_add_u32 v224, s44, v224
    s_add_u32 m0, s43, 0
    v_mfma_f32_16x16x32_bf16 v[48:51], a[176:179], a[200:203], v[48:51]
    buffer_load_dwordx4 v17, s[28:31], s76 offen offset:0 lds
    v_xor_b32 v225, 32, v224
    v_xor_b32 v226, 64, v224
    v_mfma_f32_16x16x32_bf16 v[48:51], a[184:187], a[212:215], v[48:51]
    v_xor_b32 v227, 96, v224
    v_add_u32 v228, 40960, v224
    v_mfma_f32_16x16x32_bf16 v[60:63], a[180:183], a[200:203], v[60:63]
    buffer_load_dwordx4 v18, s[28:31], s76 offen offset:1024 lds
    v_add_u32 v229, 40960, v225
    v_add_u32 v230, 40960, v226
    v_mfma_f32_16x16x32_bf16 v[60:63], a[188:191], a[212:215], v[60:63]
    v_add_u32 v231, 40960, v227
    s_xor_b32 s44, s42, 1
    s_waitcnt vmcnt(13)
    s_waitcnt lgkmcnt(0)
    s_barrier
    buffer_load_dwordx4 v19, s[28:31], s76 offen offset:2048 lds
    v_mfma_f32_16x16x32_bf16 v[40:43], a[136:139], a[152:155], v[40:43]
    ds_read_b64_tr_b16 a[176:177], v23 offset:8192
    ds_read_b64_tr_b16 a[178:179], v23 offset:9216
    ds_read_b64_tr_b16 a[180:181], v24 offset:8192
    ds_read_b64_tr_b16 a[182:183], v24 offset:9216
    v_mfma_f32_16x16x32_bf16 v[40:43], a[144:147], a[164:167], v[40:43]
    buffer_load_dwordx4 v20, s[28:31], s76 offen offset:3072 lds
    ds_read_b128 a[192:195], v29 offset:24576
    v_mfma_f32_16x16x32_bf16 v[52:55], a[140:143], a[152:155], v[52:55]
    ds_read_b128 a[196:199], v29 offset:25600
    v_mfma_f32_16x16x32_bf16 v[52:55], a[148:151], a[164:167], v[52:55]
    ds_read_b128 a[200:203], v29 offset:26624
    s_mul_i32 s44, s44, 40960
    v_add_u32 v176, s44, v36
    s_add_u32 m0, s43, 28672
    v_mfma_f32_16x16x32_bf16 v[44:47], a[136:139], a[156:159], v[44:47]
    buffer_load_dwordx4 v17, s[28:31], s77 offen offset:0 lds
    ds_read_b64_tr_b16 a[184:185], v25 offset:8192
    ds_read_b64_tr_b16 a[186:187], v25 offset:9216
    ds_read_b64_tr_b16 a[188:189], v26 offset:8192
    ds_read_b64_tr_b16 a[190:191], v26 offset:9216
    s_and_b32 s44, s42, 1
    s_lshl_b32 s44, s44, 7
    v_mfma_f32_16x16x32_bf16 v[44:47], a[144:147], a[168:171], v[44:47]
    ds_read_b128 a[204:207], v30 offset:24576
    s_lshr_b32 s45, s42, 1
    s_lshl_b32 s45, s45, 5
    v_mfma_f32_16x16x32_bf16 v[56:59], a[140:143], a[156:159], v[56:59]
    ds_read_b128 a[208:211], v30 offset:25600
    s_add_u32 s5, s44, s45
    s_add_u32 s5, s5, s4
    v_mfma_f32_16x16x32_bf16 v[56:59], a[148:151], a[168:171], v[56:59]
    buffer_load_dwordx4 v18, s[28:31], s77 offen offset:1024 lds
    ds_read_b128 a[212:215], v30 offset:26624
    s_lshl_b32 s44, s44, 7
    s_mul_i32 s45, s45, 12288
    v_mfma_f32_16x16x32_bf16 v[48:51], a[136:139], a[160:163], v[48:51]
    s_add_u32 s44, s44, s45
    v_add_u32 v9, s44, v36
    v_mfma_f32_16x16x32_bf16 v[48:51], a[144:147], a[172:175], v[48:51]
    v_add_u32 v172, s43, v36
    s_sub_u32 s44, s42, 1
    v_mfma_f32_16x16x32_bf16 v[60:63], a[140:143], a[160:163], v[60:63]
    buffer_load_dwordx4 v19, s[28:31], s77 offen offset:2048 lds
    s_and_b32 s44, s44, 3
    s_mul_i32 s44, s44, 40960
    v_mfma_f32_16x16x32_bf16 v[60:63], a[148:151], a[172:175], v[60:63]
    v_add_u32 v173, s44, v36
    s_sub_u32 s44, s42, 2
    s_waitcnt vmcnt(11)
    s_waitcnt lgkmcnt(0)
    s_barrier
    buffer_load_dwordx4 v20, s[28:31], s77 offen offset:3072 lds
    v_mfma_f32_16x16x32_bf16 v[40:43], a[176:179], a[192:195], v[40:43]
    ds_read_b64_tr_b16 a[136:137], v23 offset:16384
    ds_read_b64_tr_b16 a[138:139], v23 offset:17408
    ds_read_b64_tr_b16 a[140:141], v24 offset:16384
    ds_read_b64_tr_b16 a[142:143], v24 offset:17408
    s_add_u32 m0, s43, 32768
    v_mfma_f32_16x16x32_bf16 v[40:43], a[184:187], a[204:207], v[40:43]
    buffer_load_dwordx4 v17, s[28:31], s78 offen offset:0 lds
    ds_read_b128 a[152:155], v27 offset:36864
    v_mfma_f32_16x16x32_bf16 v[52:55], a[180:183], a[192:195], v[52:55]
    ds_read_b128 a[156:159], v27 offset:37888
    v_mfma_f32_16x16x32_bf16 v[52:55], a[188:191], a[204:207], v[52:55]
    buffer_load_dwordx4 v18, s[28:31], s78 offen offset:1024 lds
    ds_read_b128 a[160:163], v27 offset:38912
    s_and_b32 s44, s44, 3
    s_mul_i32 s44, s44, 40960
    v_mfma_f32_16x16x32_bf16 v[44:47], a[176:179], a[196:199], v[44:47]
    ds_read_b64_tr_b16 a[144:145], v25 offset:16384
    ds_read_b64_tr_b16 a[146:147], v25 offset:17408
    ds_read_b64_tr_b16 a[148:149], v26 offset:16384
    ds_read_b64_tr_b16 a[150:151], v26 offset:17408
    v_add_u32 v174, s44, v36
    v_mfma_f32_16x16x32_bf16 v[44:47], a[184:187], a[208:211], v[44:47]
    ds_read_b128 a[164:167], v28 offset:36864
    s_sub_u32 s44, s42, 3
    v_mfma_f32_16x16x32_bf16 v[56:59], a[180:183], a[196:199], v[56:59]
    buffer_load_dwordx4 v19, s[28:31], s78 offen offset:2048 lds
    ds_read_b128 a[168:171], v28 offset:37888
    s_and_b32 s44, s44, 3
    s_mul_i32 s44, s44, 40960
    v_mfma_f32_16x16x32_bf16 v[56:59], a[188:191], a[208:211], v[56:59]
    ds_read_b128 a[172:175], v28 offset:38912
    v_add_u32 v175, s44, v36
    v_mfma_f32_16x16x32_bf16 v[48:51], a[176:179], a[200:203], v[48:51]
    buffer_load_dwordx4 v20, s[28:31], s78 offen offset:3072 lds
    s_lshl_b32 s44, s48, 21
    v_mfma_f32_16x16x32_bf16 v[48:51], a[184:187], a[212:215], v[48:51]
    s_add_u32 s44, s44, s17
    s_add_u32 s60, s12, s44
    s_addc_u32 s61, s13, 0
    s_add_u32 m0, s43, 12288
    v_mfma_f32_16x16x32_bf16 v[60:63], a[180:183], a[200:203], v[60:63]
    buffer_load_dwordx4 v17, s[28:31], s79 offen offset:0 lds
    s_sub_u32 s62, 0x800000, s44
    v_mfma_f32_16x16x32_bf16 v[60:63], a[188:191], a[212:215], v[60:63]
    s_mov_b32 s63, 0x20000
    s_waitcnt vmcnt(13)
    s_waitcnt lgkmcnt(0)
    s_barrier
    buffer_load_dwordx4 v18, s[28:31], s79 offen offset:1024 lds
    v_mfma_f32_16x16x32_bf16 v[40:43], a[136:139], a[152:155], v[40:43]
    ds_read_b64_tr_b16 a[176:177], v23 offset:20480
    ds_read_b64_tr_b16 a[178:179], v23 offset:21504
    ds_read_b64_tr_b16 a[180:181], v24 offset:20480
    ds_read_b64_tr_b16 a[182:183], v24 offset:21504
    v_mfma_f32_16x16x32_bf16 v[40:43], a[144:147], a[164:167], v[40:43]
    buffer_load_dwordx4 v19, s[28:31], s79 offen offset:2048 lds
    ds_read_b128 a[192:195], v29 offset:36864
    v_mfma_f32_16x16x32_bf16 v[52:55], a[140:143], a[152:155], v[52:55]
    ds_read_b128 a[196:199], v29 offset:37888
    v_mfma_f32_16x16x32_bf16 v[52:55], a[148:151], a[164:167], v[52:55]
    ds_read_b128 a[200:203], v29 offset:38912
    v_mfma_f32_16x16x32_bf16 v[44:47], a[136:139], a[156:159], v[44:47]
    buffer_load_dwordx4 v20, s[28:31], s79 offen offset:3072 lds
    ds_read_b64_tr_b16 a[184:185], v25 offset:20480
    ds_read_b64_tr_b16 a[186:187], v25 offset:21504
    ds_read_b64_tr_b16 a[188:189], v26 offset:20480
    ds_read_b64_tr_b16 a[190:191], v26 offset:21504
    v_mfma_f32_16x16x32_bf16 v[44:47], a[144:147], a[168:171], v[44:47]
    ds_read_b128 a[204:207], v30 offset:36864
    v_mfma_f32_16x16x32_bf16 v[56:59], a[140:143], a[156:159], v[56:59]
    ds_read_b128 a[208:211], v30 offset:37888
    v_mfma_f32_16x16x32_bf16 v[56:59], a[148:151], a[168:171], v[56:59]
    buffer_store_dwordx4 v[204:207], v199, s[64:67], s8 offen offset:2048 sc1
    ds_read_b128 a[212:215], v30 offset:38912
    v_mfma_f32_16x16x32_bf16 v[48:51], a[136:139], a[160:163], v[48:51]
    v_mfma_f32_16x16x32_bf16 v[48:51], a[144:147], a[172:175], v[48:51]
    s_add_u32 m0, s43, 8192
    v_mfma_f32_16x16x32_bf16 v[60:63], a[140:143], a[160:163], v[60:63]
    buffer_load_dwordx4 v17, s[28:31], s80 offen offset:0 lds
    v_mfma_f32_16x16x32_bf16 v[60:63], a[148:151], a[172:175], v[60:63]
    buffer_load_dwordx4 v18, s[28:31], s80 offen offset:1024 lds
    s_waitcnt lgkmcnt(3)
    v_mfma_f32_16x16x32_bf16 v[40:43], a[176:179], a[192:195], v[40:43]
    s_waitcnt lgkmcnt(2)
    v_mfma_f32_16x16x32_bf16 v[40:43], a[184:187], a[204:207], v[40:43]
    v_mfma_f32_16x16x32_bf16 v[52:55], a[180:183], a[192:195], v[52:55]
    v_mfma_f32_16x16x32_bf16 v[52:55], a[188:191], a[204:207], v[52:55]
    buffer_load_dwordx4 v19, s[28:31], s80 offen offset:2048 lds
    v_mfma_f32_16x16x32_bf16 v[44:47], a[176:179], a[196:199], v[44:47]
    s_waitcnt lgkmcnt(0)
    v_mfma_f32_16x16x32_bf16 v[44:47], a[184:187], a[208:211], v[44:47]
    v_mfma_f32_16x16x32_bf16 v[56:59], a[180:183], a[196:199], v[56:59]
    v_mfma_f32_16x16x32_bf16 v[56:59], a[188:191], a[208:211], v[56:59]
    buffer_load_dwordx4 v20, s[28:31], s80 offen offset:3072 lds
    v_mfma_f32_16x16x32_bf16 v[48:51], a[176:179], a[200:203], v[48:51]
    v_mfma_f32_16x16x32_bf16 v[48:51], a[184:187], a[212:215], v[48:51]
    v_mfma_f32_16x16x32_bf16 v[60:63], a[180:183], a[200:203], v[60:63]
    v_mfma_f32_16x16x32_bf16 v[60:63], a[188:191], a[212:215], v[60:63]
    v_cvt_pk_bf16_f32 v40, v40, v41
    v_cvt_pk_bf16_f32 v41, v42, v43
    ds_write_b64 v35, v[40:41] offset:4096
    v_cvt_pk_bf16_f32 v52, v52, v53
    v_cvt_pk_bf16_f32 v53, v54, v55
    ds_write_b64 v35, v[52:53] offset:4608
    v_cvt_pk_bf16_f32 v44, v44, v45
    v_cvt_pk_bf16_f32 v45, v46, v47
    s_add_u32 m0, s43, 24576
    ds_write_b64 v35, v[44:45] offset:5120
    buffer_load_dwordx4 v17, s[28:31], s81 offen offset:0 lds
    v_cvt_pk_bf16_f32 v56, v56, v57
    v_cvt_pk_bf16_f32 v57, v58, v59
    ds_write_b64 v35, v[56:57] offset:5632
    buffer_load_dwordx4 v18, s[28:31], s81 offen offset:1024 lds
    v_cvt_pk_bf16_f32 v48, v48, v49
    v_cvt_pk_bf16_f32 v49, v50, v51
    ds_write_b64 v35, v[48:49] offset:6144
    v_cvt_pk_bf16_f32 v60, v60, v61
    v_cvt_pk_bf16_f32 v61, v62, v63
    ds_write_b64 v35, v[60:61] offset:6656
L_pad1:
    s_cbranch_execz L_warm_ret
    s_nop 0
    buffer_load_dwordx4 v19, s[28:31], s81 offen offset:2048 lds
    s_waitcnt lgkmcnt(0)
    s_barrier
    s_waitcnt vmcnt(20)
    ds_read_b128 a[136:139], v31 offset:0
    ds_read_b128 a[140:143], v32 offset:0
    ds_read_b128 a[144:147], v33 offset:0
    ds_read_b128 a[148:151], v34 offset:0
    ds_read_b128 a[0:3], v36 offset:4096
    ds_read_b128 a[12:15], v37 offset:4096
    ds_read_b128 a[24:27], v38 offset:4096
    ds_read_b128 a[36:39], v39 offset:4096
    buffer_load_dwordx4 v20, s[28:31], s81 offen offset:3072 lds
    ds_read_b128 a[4:7], v36 offset:5120
    ds_read_b128 a[16:19], v37 offset:5120
    s_add_u32 m0, s43, 16384
    ds_read_b128 a[28:31], v38 offset:5120
    buffer_load_dwordx4 v17, s[28:31], s82 offen offset:0 lds
    ds_read_b128 a[40:43], v39 offset:5120
    ds_read_b128 a[8:11], v36 offset:6144
    ds_read_b128 a[20:23], v37 offset:6144
    buffer_load_dwordx4 v18, s[28:31], s82 offen offset:1024 lds
    ds_read_b128 a[32:35], v38 offset:6144
    ds_read_b128 a[44:47], v39 offset:6144
L_att:
    s_waitcnt lgkmcnt(8)
    v_mfma_f32_16x16x32_bf16 v[64:67], a[136:139], a[0:3], 0
    buffer_load_dwordx4 v19, s[28:31], s82 offen offset:2048 lds
    v_mul_u32_u24 v13, 4, v4
    v_mfma_f32_16x16x32_bf16 v[64:67], a[140:143], a[12:15], v[64:67]
    s_waitcnt vmcnt(20)
    ds_read_b128 a[152:155], v31 offset:28672
    ds_read_b128 a[156:159], v32 offset:28672
    v_mfma_f32_16x16x32_bf16 v[64:67], a[144:147], a[24:27], v[64:67]
    v_mfma_f32_16x16x32_bf16 v[64:67], a[148:151], a[36:39], v[64:67]
    buffer_load_dwordx4 v20, s[28:31], s82 offen offset:3072 lds
    v_lshlrev_b32 v14, 2, v4
    s_waitcnt lgkmcnt(2)
    v_mfma_f32_16x16x32_bf16 v[72:75], a[136:139], a[4:7], 0
    v_mfma_f32_16x16x32_bf16 v[72:75], a[140:143], a[16:19], v[72:75]
    ds_read_b128 a[160:163], v33 offset:28672
    ds_read_b128 a[164:167], v34 offset:28672
    s_add_u32 m0, s43, 20480
    v_mfma_f32_16x16x32_bf16 v[72:75], a[144:147], a[28:31], v[72:75]
    buffer_load_dwordx4 v17, s[28:31], s83 offen offset:0 lds
    v_and_b32 v5, 32, v13
    v_mfma_f32_16x16x32_bf16 v[72:75], a[148:151], a[40:43], v[72:75]
    v_mfma_f32_16x16x32_bf16 v[80:83], a[136:139], a[8:11], 0
    v_mfma_f32_16x16x32_bf16 v[80:83], a[140:143], a[20:23], v[80:83]
    buffer_load_dwordx4 v18, s[28:31], s83 offen offset:1024 lds
    v_add_u32 v13, v13, v5
    v_mfma_f32_16x16x32_bf16 v[80:83], a[144:147], a[32:35], v[80:83]
    v_mfma_f32_16x16x32_bf16 v[80:83], a[148:151], a[44:47], v[80:83]
    s_waitcnt lgkmcnt(2)
    v_mfma_f32_16x16x32_bf16 v[68:71], a[152:155], a[0:3], 0
    buffer_load_dwordx4 v19, s[28:31], s83 offen offset:2048 lds
    v_mfma_f32_16x16x32_bf16 v[68:71], a[156:159], a[12:15], v[68:71]
    s_waitcnt vmcnt(20)
    ds_read_b128 a[136:139], v31 offset:32768
    ds_read_b128 a[140:143], v32 offset:32768
    s_waitcnt lgkmcnt(2)
    v_mfma_f32_16x16x32_bf16 v[68:71], a[160:163], a[24:27], v[68:71]
    buffer_load_dwordx4 v20, s[28:31], s83 offen offset:3072 lds
    v_mfma_f32_16x16x32_bf16 v[68:71], a[164:167], a[36:39], v[68:71]
    v_mfma_f32_16x16x32_bf16 v[76:79], a[152:155], a[4:7], 0
    v_mfma_f32_16x16x32_bf16 v[76:79], a[156:159], a[16:19], v[76:79]
    buffer_load_dword v250, v1, s[68:71], 0 offen sc1
    ds_read_b128 a[144:147], v33 offset:32768
    ds_read_b128 a[148:151], v34 offset:32768
    v_mfma_f32_16x16x32_bf16 v[76:79], a[160:163], a[28:31], v[76:79]
    s_add_u32 m0, s43, 36864
    v_mfma_f32_16x16x32_bf16 v[76:79], a[164:167], a[40:43], v[76:79]
    buffer_load_dwordx4 v21, s[32:35], s76 offen offset:0 lds
    v_mfma_f32_16x16x32_bf16 v[84:87], a[152:155], a[8:11], 0
    v_mfma_f32_16x16x32_bf16 v[84:87], a[156:159], a[20:23], v[84:87]
    v_mfma_f32_16x16x32_bf16 v[84:87], a[160:163], a[32:35], v[84:87]
    buffer_load_dwordx4 v22, s[32:35], s76 offen offset:1024 lds
    v_mfma_f32_16x16x32_bf16 v[84:87], a[164:167], a[44:47], v[84:87]
    s_waitcnt lgkmcnt(2)
    v_mfma_f32_16x16x32_bf16 v[88:91], a[136:139], a[0:3], 0
    buffer_load_dwordx4 v21, s[32:35], s76 offen offset:2048 lds
    v_max3_f32 v10, v64, v65, v66
    v_max3_f32 v5, v67, v68, v69
    v_max3_f32 v11, v72, v73, v74
    v_mfma_f32_16x16x32_bf16 v[88:91], a[140:143], a[12:15], v[88:91]
    s_waitcnt vmcnt(21)
    ds_read_b128 a[152:155], v31 offset:12288
    ds_read_b128 a[156:159], v32 offset:12288
    v_max3_f32 v6, v75, v76, v77
    v_max3_f32 v12, v80, v81, v82
    v_max3_f32 v7, v83, v84, v85
    s_waitcnt lgkmcnt(2)
    v_mfma_f32_16x16x32_bf16 v[88:91], a[144:147], a[24:27], v[88:91]
    v_max3_f32 v10, v10, v70, v71
    v_max3_f32 v11, v11, v78, v79
    v_mfma_f32_16x16x32_bf16 v[88:91], a[148:151], a[36:39], v[88:91]
    buffer_load_dwordx4 v22, s[32:35], s76 offen offset:3072 lds
    v_max3_f32 v12, v12, v86, v87
    v_max3_f32 v10, v10, v5, v220
    v_max3_f32 v11, v11, v6, v221
    v_mfma_f32_16x16x32_bf16 v[96:99], a[136:139], a[4:7], 0
    v_max3_f32 v12, v12, v7, v222
    v_mov_b32 v5, v10
    v_mfma_f32_16x16x32_bf16 v[96:99], a[140:143], a[16:19], v[96:99]
    ds_read_b128 a[160:163], v33 offset:12288
    ds_read_b128 a[164:167], v34 offset:12288
    v_mov_b32 v6, v11
    v_mov_b32 v7, v12
    v_permlane32_swap_b32 v10, v5
    s_add_u32 m0, s43, 0
    v_mfma_f32_16x16x32_bf16 v[96:99], a[144:147], a[28:31], v[96:99]
    buffer_load_dwordx4 v21, s[32:35], s77 offen offset:0 lds
    v_permlane32_swap_b32 v11, v6
    v_permlane32_swap_b32 v12, v7
    v_max_f32 v10, v10, v5
    v_mfma_f32_16x16x32_bf16 v[96:99], a[148:151], a[40:43], v[96:99]
    v_max_f32 v11, v11, v6
    v_max_f32 v12, v12, v7
    v_mfma_f32_16x16x32_bf16 v[104:107], a[136:139], a[8:11], 0
    v_mov_b32 v5, v10
    v_mov_b32 v6, v11
    v_mov_b32 v7, v12
    v_mfma_f32_16x16x32_bf16 v[104:107], a[140:143], a[20:23], v[104:107]
    buffer_load_dwordx4 v22, s[32:35], s77 offen offset:1024 lds
    v_permlane16_swap_b32 v10, v5
    v_permlane16_swap_b32 v11, v6
    v_mfma_f32_16x16x32_bf16 v[104:107], a[144:147], a[32:35], v[104:107]
    v_permlane16_swap_b32 v12, v7
    v_max_f32 v10, v10, v5
    v_max_f32 v11, v11, v6
    v_mfma_f32_16x16x32_bf16 v[104:107], a[148:151], a[44:47], v[104:107]
    v_max_f32 v12, v12, v7
    ds_write_b96 v172, v[10:12] offset:7168
    s_waitcnt lgkmcnt(0)
    s_barrier
    ds_read_b96 v[208:210], v173 offset:7168
    ds_read_b96 v[212:214], v174 offset:7168
    ds_read_b96 v[216:218], v175 offset:7168
    v_mfma_f32_16x16x32_bf16 v[92:95], a[152:155], a[0:3], 0
    buffer_load_dwordx4 v21, s[32:35], s77 offen offset:2048 lds
    v_mfma_f32_16x16x32_bf16 v[92:95], a[156:159], a[12:15], v[92:95]
    v_mfma_f32_16x16x32_bf16 v[92:95], a[160:163], a[24:27], v[92:95]
    buffer_load_dwordx4 v22, s[32:35], s77 offen offset:3072 lds
    v_mfma_f32_16x16x32_bf16 v[92:95], a[164:167], a[36:39], v[92:95]
    v_mfma_f32_16x16x32_bf16 v[100:103], a[152:155], a[4:7], 0
    s_waitcnt lgkmcnt(1)
    v_max3_f32 v10, v10, v208, v212
    s_add_u32 m0, s43, 28672
    v_mfma_f32_16x16x32_bf16 v[100:103], a[156:159], a[16:19], v[100:103]
    buffer_load_dwordx4 v17, s[28:31], s84 offen offset:0 lds
    v_max3_f32 v11, v11, v209, v213
    v_mfma_f32_16x16x32_bf16 v[100:103], a[160:163], a[28:31], v[100:103]
    v_max3_f32 v12, v12, v210, v214
    v_mfma_f32_16x16x32_bf16 v[100:103], a[164:167], a[40:43], v[100:103]
    buffer_load_dwordx4 v18, s[28:31], s84 offen offset:1024 lds
    s_waitcnt lgkmcnt(0)
    v_max_f32 v10, v10, v216
    v_mfma_f32_16x16x32_bf16 v[108:111], a[152:155], a[8:11], 0
    s_waitcnt vmcnt(23)
    ds_read_b128 a[136:139], v31 offset:8192
    ds_read_b128 a[140:143], v32 offset:8192
    v_max_f32 v11, v11, v217
    v_max_f32 v12, v12, v218
    v_mfma_f32_16x16x32_bf16 v[108:111], a[156:159], a[20:23], v[108:111]
    ds_read_b128 a[144:147], v33 offset:8192
    ds_read_b128 a[148:151], v34 offset:8192
    v_mul_f32 v10, s58, v10
    v_mfma_f32_16x16x32_bf16 v[108:111], a[160:163], a[32:35], v[108:111]
    buffer_load_dwordx4 v19, s[28:31], s84 offen offset:2048 lds
    v_mul_f32 v11, s58, v11
    v_mfma_f32_16x16x32_bf16 v[108:111], a[164:167], a[44:47], v[108:111]
    v_mul_f32 v12, s58, v12
    s_waitcnt lgkmcnt(3)
    v_mfma_f32_16x16x32_bf16 v[112:115], a[136:139], a[0:3], 0
    buffer_load_dwordx4 v20, s[28:31], s84 offen offset:3072 lds
    v_fma_f32 v64, v64, s58, -v10
    v_fma_f32 v65, v65, s58, -v10
    v_exp_f32 v64, v64
    s_waitcnt lgkmcnt(2)
    v_mfma_f32_16x16x32_bf16 v[112:115], a[140:143], a[12:15], v[112:115]
    s_waitcnt vmcnt(21)
    ds_read_b128 a[152:155], v31 offset:24576
    ds_read_b128 a[156:159], v32 offset:24576
    v_fma_f32 v66, v66, s58, -v10
    v_exp_f32 v65, v65
    s_add_u32 m0, s43, 32768
    s_waitcnt lgkmcnt(2)
    v_mfma_f32_16x16x32_bf16 v[112:115], a[144:147], a[24:27], v[112:115]
    buffer_load_dwordx4 v17, s[28:31], s85 offen offset:0 lds
    v_fma_f32 v67, v67, s58, -v10
    v_exp_f32 v66, v66
    v_fma_f32 v68, v68, s58, -v10
    v_mfma_f32_16x16x32_bf16 v[112:115], a[148:151], a[36:39], v[112:115]
    v_exp_f32 v67, v67
    v_cvt_pk_bf16_f32 v64, v64, v65
    v_mfma_f32_16x16x32_bf16 v[120:123], a[136:139], a[4:7], 0
    v_fma_f32 v69, v69, s58, -v10
    v_exp_f32 v68, v68
    v_fma_f32 v70, v70, s58, -v10
    v_mfma_f32_16x16x32_bf16 v[120:123], a[140:143], a[16:19], v[120:123]
    buffer_load_dwordx4 v18, s[28:31], s85 offen offset:1024 lds
    ds_read_b128 a[160:163], v33 offset:24576
    ds_read_b128 a[164:167], v34 offset:24576
    v_exp_f32 v69, v69
    v_cvt_pk_bf16_f32 v65, v66, v67
    v_mfma_f32_16x16x32_bf16 v[120:123], a[144:147], a[28:31], v[120:123]
    v_fma_f32 v71, v71, s58, -v10
    v_exp_f32 v70, v70
    v_exp_f32 v71, v71
    v_mfma_f32_16x16x32_bf16 v[120:123], a[148:151], a[40:43], v[120:123]
    buffer_load_dwordx4 v19, s[28:31], s85 offen offset:2048 lds
    v_cvt_pk_bf16_f32 v66, v68, v69
    v_cvt_pk_bf16_f32 v67, v70, v71
    v_mfma_f32_16x16x32_bf16 v[128:131], a[136:139], a[8:11], 0
    v_fma_f32 v72, v72, s58, -v11
    v_fma_f32 v73, v73, s58, -v11
    v_exp_f32 v72, v72
    v_mfma_f32_16x16x32_bf16 v[128:131], a[140:143], a[20:23], v[128:131]
    v_fma_f32 v74, v74, s58, -v11
    v_exp_f32 v73, v73
    v_mfma_f32_16x16x32_bf16 v[128:131], a[144:147], a[32:35], v[128:131]
    buffer_load_dwordx4 v20, s[28:31], s85 offen offset:3072 lds
    v_fma_f32 v75, v75, s58, -v11
    v_exp_f32 v74, v74
    v_fma_f32 v76, v76, s58, -v11
    v_mfma_f32_16x16x32_bf16 v[128:131], a[148:151], a[44:47], v[128:131]
    v_exp_f32 v75, v75
    v_cvt_pk_bf16_f32 v72, v72, v73
    s_barrier
    s_add_u32 m0, s43, 12288
    s_waitcnt lgkmcnt(0)
    v_mfma_f32_16x16x32_bf16 v[116:119], a[152:155], a[0:3], 0
    buffer_load_dwordx4 v21, s[32:35], s78 offen offset:0 lds
    v_fma_f32 v77, v77, s58, -v11
    v_exp_f32 v76, v76
    v_fma_f32 v78, v78, s58, -v11
    v_mfma_f32_16x16x32_bf16 v[116:119], a[156:159], a[12:15], v[116:119]
    s_waitcnt vmcnt(22)
    ds_read_b128 a[136:139], v31 offset:16384
    ds_read_b128 a[140:143], v32 offset:16384
    v_exp_f32 v77, v77
    v_cvt_pk_bf16_f32 v73, v74, v75
    v_mfma_f32_16x16x32_bf16 v[116:119], a[160:163], a[24:27], v[116:119]
    buffer_load_dwordx4 v22, s[32:35], s78 offen offset:1024 lds
    v_fma_f32 v79, v79, s58, -v11
    v_exp_f32 v78, v78
    v_exp_f32 v79, v79
    v_mfma_f32_16x16x32_bf16 v[116:119], a[164:167], a[36:39], v[116:119]
    v_cvt_pk_bf16_f32 v74, v76, v77
    v_cvt_pk_bf16_f32 v75, v78, v79
    v_mfma_f32_16x16x32_bf16 v[124:127], a[152:155], a[4:7], 0
    buffer_load_dwordx4 v21, s[32:35], s78 offen offset:2048 lds
    v_fma_f32 v80, v80, s58, -v12
    v_fma_f32 v81, v81, s58, -v12
    v_exp_f32 v80, v80
    v_mfma_f32_16x16x32_bf16 v[124:127], a[156:159], a[16:19], v[124:127]
    ds_read_b128 a[144:147], v33 offset:16384
    ds_read_b128 a[148:151], v34 offset:16384
    v_fma_f32 v82, v82, s58, -v12
    v_exp_f32 v81, v81
    v_mfma_f32_16x16x32_bf16 v[124:127], a[160:163], a[28:31], v[124:127]
    buffer_load_dwordx4 v22, s[32:35], s78 offen offset:3072 lds
    v_fma_f32 v83, v83, s58, -v12
    v_exp_f32 v82, v82
    v_fma_f32 v84, v84, s58, -v12
    v_mfma_f32_16x16x32_bf16 v[124:127], a[164:167], a[40:43], v[124:127]
    v_exp_f32 v83, v83
    v_cvt_pk_bf16_f32 v80, v80, v81
    s_add_u32 m0, s43, 8192
    v_mfma_f32_16x16x32_bf16 v[132:135], a[152:155], a[8:11], 0
    buffer_load_dwordx4 v21, s[32:35], s79 offen offset:0 lds
    v_fma_f32 v85, v85, s58, -v12
    v_exp_f32 v84, v84
    v_fma_f32 v86, v86, s58, -v12
    v_mfma_f32_16x16x32_bf16 v[132:135], a[156:159], a[20:23], v[132:135]
    v_exp_f32 v85, v85
    v_cvt_pk_bf16_f32 v81, v82, v83
    v_mfma_f32_16x16x32_bf16 v[132:135], a[160:163], a[32:35], v[132:135]
    buffer_load_dwordx4 v22, s[32:35], s79 offen offset:1024 lds
    v_fma_f32 v87, v87, s58, -v12
    v_exp_f32 v86, v86
    v_exp_f32 v87, v87
    v_mfma_f32_16x16x32_bf16 v[132:135], a[164:167], a[44:47], v[132:135]
    v_cvt_pk_bf16_f32 v82, v84, v85
    v_cvt_pk_bf16_f32 v83, v86, v87
    s_waitcnt vmcnt(23)
    ds_read_b128 a[152:155], v31 offset:20480
    ds_read_b128 a[156:159], v32 offset:20480
    ds_read_b128 a[160:163], v33 offset:20480
    ds_read_b128 a[164:167], v34 offset:20480
    s_waitcnt lgkmcnt(4)
    v_mfma_f32_16x16x32_bf16 v[136:139], a[136:139], a[0:3], 0
    buffer_load_dwordx4 v21, s[32:35], s79 offen offset:2048 lds
    v_fma_f32 v88, v88, s58, -v10
    v_fma_f32 v89, v89, s58, -v10
    v_mfma_f32_16x16x32_bf16 v[136:139], a[140:143], a[12:15], v[136:139]
    s_waitcnt vmcnt(19)
    ds_read_b64_tr_b16 a[168:169], v160 offset:36864
    ds_read_b64_tr_b16 a[172:173], v161 offset:36864
    v_exp_f32 v88, v88
    v_mfma_f32_16x16x32_bf16 v[136:139], a[144:147], a[24:27], v[136:139]
    v_fma_f32 v90, v90, s58, -v10
    v_mfma_f32_16x16x32_bf16 v[136:139], a[148:151], a[36:39], v[136:139]
    buffer_load_dwordx4 v22, s[32:35], s79 offen offset:3072 lds
    ds_read_b64_tr_b16 a[176:177], v162 offset:36864
    ds_read_b64_tr_b16 a[180:181], v163 offset:36864
    v_exp_f32 v89, v89
    v_mfma_f32_16x16x32_bf16 v[144:147], a[136:139], a[4:7], 0
    v_fma_f32 v91, v91, s58, -v10
    v_mfma_f32_16x16x32_bf16 v[144:147], a[140:143], a[16:19], v[144:147]
    ds_read_b64_tr_b16 a[184:185], v164 offset:36864
    ds_read_b64_tr_b16 a[188:189], v165 offset:36864
    v_exp_f32 v90, v90
    v_mfma_f32_16x16x32_bf16 v[144:147], a[144:147], a[28:31], v[144:147]
    v_cmp_eq_u32 vcc, 0, v250
    s_cbranch_vccnz L_arr_slow
L_arr_ok:
    s_cmp_lg_u32 s42, 0
    s_cbranch_scc1 L_sk3
    buffer_store_dword v196, v194, s[64:67], s4 offen offset:256 sc1
L_sk3:
    v_fma_f32 v92, v92, s58, -v10
    v_exp_f32 v91, v91
    v_mfma_f32_16x16x32_bf16 v[144:147], a[148:151], a[40:43], v[144:147]
    ds_read_b64_tr_b16 a[192:193], v166 offset:36864
    ds_read_b64_tr_b16 a[196:197], v167 offset:36864
    v_cvt_pk_bf16_f32 v88, v88, v89
    v_mfma_f32_16x16x32_bf16 v[152:155], a[136:139], a[8:11], 0
    v_fma_f32 v93, v93, s58, -v10
    s_add_u32 m0, s43, 24576
    v_mfma_f32_16x16x32_bf16 v[152:155], a[140:143], a[20:23], v[152:155]
    buffer_load_dwordx4 v17, s[28:31], s86 offen offset:0 lds
    v_exp_f32 v92, v92
    v_mfma_f32_16x16x32_bf16 v[152:155], a[144:147], a[32:35], v[152:155]
    v_fma_f32 v94, v94, s58, -v10
    v_mfma_f32_16x16x32_bf16 v[152:155], a[148:151], a[44:47], v[152:155]
    v_exp_f32 v93, v93
    s_waitcnt lgkmcnt(2)
    v_mfma_f32_16x16x32_bf16 v[140:143], a[152:155], a[0:3], 0
    buffer_load_dwordx4 v18, s[28:31], s86 offen offset:1024 lds
    v_cvt_pk_bf16_f32 v89, v90, v91
    v_fma_f32 v95, v95, s58, -v10
    v_mfma_f32_16x16x32_bf16 v[140:143], a[156:159], a[12:15], v[140:143]
    s_waitcnt vmcnt(18)
    ds_read_b64_tr_b16 a[170:171], v160 offset:0
    ds_read_b64_tr_b16 a[174:175], v161 offset:0
    v_exp_f32 v94, v94
    v_mfma_f32_16x16x32_bf16 v[140:143], a[160:163], a[24:27], v[140:143]
    v_exp_f32 v95, v95
    v_mfma_f32_16x16x32_bf16 v[140:143], a[164:167], a[36:39], v[140:143]
    buffer_load_dwordx4 v19, s[28:31], s86 offen offset:2048 lds
    ds_read_b64_tr_b16 a[178:179], v162 offset:0
    ds_read_b64_tr_b16 a[182:183], v163 offset:0
    v_cvt_pk_bf16_f32 v90, v92, v93
    v_mfma_f32_16x16x32_bf16 v[148:151], a[152:155], a[4:7], 0
    v_cvt_pk_bf16_f32 v91, v94, v95
    v_mfma_f32_16x16x32_bf16 v[148:151], a[156:159], a[16:19], v[148:151]
    ds_read_b64_tr_b16 a[186:187], v164 offset:0
    ds_read_b64_tr_b16 a[190:191], v165 offset:0
    v_fma_f32 v96, v96, s58, -v11
    v_mfma_f32_16x16x32_bf16 v[148:151], a[160:163], a[28:31], v[148:151]
    buffer_load_dwordx4 v20, s[28:31], s86 offen offset:3072 lds
    v_fma_f32 v97, v97, s58, -v11
    v_exp_f32 v96, v96
    v_mfma_f32_16x16x32_bf16 v[148:151], a[164:167], a[40:43], v[148:151]
    ds_read_b64_tr_b16 a[194:195], v166 offset:0
    ds_read_b64_tr_b16 a[198:199], v167 offset:0
    v_fma_f32 v98, v98, s58, -v11
    v_mfma_f32_16x16x32_bf16 v[156:159], a[152:155], a[8:11], 0
    v_exp_f32 v97, v97
    s_add_u32 m0, s43, 4096
    v_mfma_f32_16x16x32_bf16 v[156:159], a[156:159], a[20:23], v[156:159]
    buffer_load_dwordx4 v17, s[28:31], s87 offen offset:0 lds
    v_fma_f32 v99, v99, s58, -v11
    v_mfma_f32_16x16x32_bf16 v[156:159], a[160:163], a[32:35], v[156:159]
    v_exp_f32 v98, v98
    v_mfma_f32_16x16x32_bf16 v[156:159], a[164:167], a[44:47], v[156:159]
    v_fma_f32 v100, v100, s58, -v11
    v_mfma_f32_16x16x32_bf16 v[180:183], a[132:135], v[64:67], 0
    buffer_load_dwordx4 v18, s[28:31], s87 offen offset:1024 lds
    v_exp_f32 v99, v99
    v_cvt_pk_bf16_f32 v96, v96, v97
    v_mfma_f32_16x16x32_bf16 v[184:187], a[132:135], v[72:75], 0
    v_fma_f32 v101, v101, s58, -v11
    v_mfma_f32_16x16x32_bf16 v[188:191], a[132:135], v[80:83], 0
    v_exp_f32 v100, v100
    s_waitcnt lgkmcnt(0)
    v_mfma_f32_16x16x32_bf16 v[40:43], a[168:171], v[64:67], 0
    buffer_load_dwordx4 v19, s[28:31], s87 offen offset:2048 lds
    v_fma_f32 v102, v102, s58, -v11
    v_mfma_f32_16x16x32_bf16 v[44:47], a[168:171], v[72:75], 0
    s_waitcnt vmcnt(19)
    ds_read_b128 a[136:139], v31 offset:28672
    ds_read_b128 a[140:143], v32 offset:28672
    v_exp_f32 v101, v101
    v_cvt_pk_bf16_f32 v97, v98, v99
    v_mfma_f32_16x16x32_bf16 v[48:51], a[168:171], v[80:83], 0
    v_fma_f32 v103, v103, s58, -v11
    v_mfma_f32_16x16x32_bf16 v[52:55], a[172:175], v[64:67], 0
    v_exp_f32 v102, v102
    v_mfma_f32_16x16x32_bf16 v[56:59], a[172:175], v[72:75], 0
    buffer_load_dwordx4 v20, s[28:31], s87 offen offset:3072 lds
    ds_read_b128 a[144:147], v33 offset:28672
    ds_read_b128 a[148:151], v34 offset:28672
    v_exp_f32 v103, v103
    v_mfma_f32_16x16x32_bf16 v[60:63], a[172:175], v[80:83], 0
    v_cvt_pk_bf16_f32 v98, v100, v101
    v_cvt_pk_bf16_f32 v99, v102, v103
    v_mfma_f32_16x16x32_bf16 a[48:51], a[176:179], v[64:67], 0
    v_fma_f32 v104, v104, s58, -v12
    s_add_u32 m0, s43, 16384
    v_mfma_f32_16x16x32_bf16 a[52:55], a[176:179], v[72:75], 0
    buffer_load_dwordx4 v21, s[32:35], s80 offen offset:0 lds
    v_fma_f32 v105, v105, s58, -v12
    v_mfma_f32_16x16x32_bf16 a[56:59], a[176:179], v[80:83], 0
    v_exp_f32 v104, v104
    v_mfma_f32_16x16x32_bf16 a[60:63], a[180:183], v[64:67], 0
    v_fma_f32 v106, v106, s58, -v12
    v_mfma_f32_16x16x32_bf16 a[64:67], a[180:183], v[72:75], 0
    buffer_load_dwordx4 v22, s[32:35], s80 offen offset:1024 lds
    v_exp_f32 v105, v105
    v_fma_f32 v107, v107, s58, -v12
    v_mfma_f32_16x16x32_bf16 a[68:71], a[180:183], v[80:83], 0
    v_exp_f32 v106, v106
    v_mfma_f32_16x16x32_bf16 a[72:75], a[184:187], v[64:67], 0
    v_fma_f32 v108, v108, s58, -v12
    v_mfma_f32_16x16x32_bf16 a[76:79], a[184:187], v[72:75], 0
    buffer_load_dwordx4 v21, s[32:35], s80 offen offset:2048 lds
    v_exp_f32 v107, v107
    v_mfma_f32_16x16x32_bf16 a[80:83], a[184:187], v[80:83], 0
    s_waitcnt vmcnt(19)
    ds_read_b128 a[152:155], v31 offset:32768
    ds_read_b128 a[156:159], v32 offset:32768
    v_cvt_pk_bf16_f32 v104, v104, v105
    v_mfma_f32_16x16x32_bf16 a[84:87], a[188:191], v[64:67], 0
    v_fma_f32 v109, v109, s58, -v12
    v_mfma_f32_16x16x32_bf16 a[88:91], a[188:191], v[72:75], 0
    v_exp_f32 v108, v108
    v_mfma_f32_16x16x32_bf16 a[92:95], a[188:191], v[80:83], 0
    buffer_load_dwordx4 v22, s[32:35], s80 offen offset:3072 lds
    v_fma_f32 v110, v110, s58, -v12
    v_exp_f32 v109, v109
    v_mfma_f32_16x16x32_bf16 a[96:99], a[192:195], v[64:67], 0
    ds_read_b128 a[160:163], v33 offset:32768
    ds_read_b128 a[164:167], v34 offset:32768
    v_cvt_pk_bf16_f32 v105, v106, v107
    v_mfma_f32_16x16x32_bf16 a[100:103], a[192:195], v[72:75], 0
    v_fma_f32 v111, v111, s58, -v12
    v_mfma_f32_16x16x32_bf16 a[104:107], a[192:195], v[80:83], 0
    v_exp_f32 v110, v110
    s_add_u32 m0, s43, 20480
    v_mfma_f32_16x16x32_bf16 a[108:111], a[196:199], v[64:67], 0
    buffer_load_dwordx4 v21, s[32:35], s81 offen offset:0 lds
    v_exp_f32 v111, v111
    v_mfma_f32_16x16x32_bf16 a[112:115], a[196:199], v[72:75], 0
    v_cvt_pk_bf16_f32 v106, v108, v109
    v_mfma_f32_16x16x32_bf16 a[116:119], a[196:199], v[80:83], 0
    v_cvt_pk_bf16_f32 v107, v110, v111
    s_waitcnt lgkmcnt(1)
    v_mfma_f32_16x16x32_bf16 v[64:67], a[136:139], a[0:3], 0
    buffer_load_dwordx4 v22, s[32:35], s81 offen offset:1024 lds
    v_fma_f32 v112, v112, s58, -v10
    v_fma_f32 v113, v113, s58, -v10
    v_mfma_f32_16x16x32_bf16 v[64:67], a[140:143], a[12:15], v[64:67]
    s_waitcnt vmcnt(18)
    ds_read_b64_tr_b16 a[168:169], v160 offset:12288
    ds_read_b64_tr_b16 a[172:173], v161 offset:12288
    v_exp_f32 v112, v112
    v_mfma_f32_16x16x32_bf16 v[64:67], a[144:147], a[24:27], v[64:67]
    v_fma_f32 v114, v114, s58, -v10
    v_mfma_f32_16x16x32_bf16 v[64:67], a[148:151], a[36:39], v[64:67]
    buffer_load_dwordx4 v21, s[32:35], s81 offen offset:2048 lds
    ds_read_b64_tr_b16 a[176:177], v162 offset:12288
    ds_read_b64_tr_b16 a[180:181], v163 offset:12288
    v_exp_f32 v113, v113
    v_mfma_f32_16x16x32_bf16 v[72:75], a[136:139], a[4:7], 0
    v_fma_f32 v115, v115, s58, -v10
    v_mfma_f32_16x16x32_bf16 v[72:75], a[140:143], a[16:19], v[72:75]
    ds_read_b64_tr_b16 a[184:185], v164 offset:12288
    ds_read_b64_tr_b16 a[188:189], v165 offset:12288
    v_exp_f32 v114, v114
    v_mfma_f32_16x16x32_bf16 v[72:75], a[144:147], a[28:31], v[72:75]
    buffer_load_dwordx4 v22, s[32:35], s81 offen offset:3072 lds
    v_fma_f32 v116, v116, s58, -v10
    v_exp_f32 v115, v115
    v_mfma_f32_16x16x32_bf16 v[72:75], a[148:151], a[40:43], v[72:75]
    ds_read_b64_tr_b16 a[192:193], v166 offset:12288
    ds_read_b64_tr_b16 a[196:197], v167 offset:12288
    v_cvt_pk_bf16_f32 v112, v112, v113
    v_mfma_f32_16x16x32_bf16 v[80:83], a[136:139], a[8:11], 0
    v_fma_f32 v117, v117, s58, -v10
    s_add_u32 m0, s43, 36864
    v_mfma_f32_16x16x32_bf16 v[80:83], a[140:143], a[20:23], v[80:83]
    buffer_load_dwordx4 v17, s[28:31], s88 offen offset:0 lds
    v_exp_f32 v116, v116
    v_mfma_f32_16x16x32_bf16 v[80:83], a[144:147], a[32:35], v[80:83]
    v_fma_f32 v118, v118, s58, -v10
    v_mfma_f32_16x16x32_bf16 v[80:83], a[148:151], a[44:47], v[80:83]
    v_exp_f32 v117, v117
    v_mfma_f32_16x16x32_bf16 v[68:71], a[152:155], a[0:3], 0
    buffer_load_dwordx4 v18, s[28:31], s88 offen offset:1024 lds
    v_cvt_pk_bf16_f32 v113, v114, v115
    v_fma_f32 v119, v119, s58, -v10
    v_mfma_f32_16x16x32_bf16 v[68:71], a[156:159], a[12:15], v[68:71]
    s_waitcnt vmcnt(18)
    ds_read_b64_tr_b16 a[170:171], v160 offset:8192
    ds_read_b64_tr_b16 a[174:175], v161 offset:8192
    v_exp_f32 v118, v118
    v_mfma_f32_16x16x32_bf16 v[68:71], a[160:163], a[24:27], v[68:71]
    v_exp_f32 v119, v119
    s_waitcnt lgkmcnt(2)
    v_mfma_f32_16x16x32_bf16 v[68:71], a[164:167], a[36:39], v[68:71]
    buffer_load_dwordx4 v19, s[28:31], s88 offen offset:2048 lds
    ds_read_b64_tr_b16 a[178:179], v162 offset:8192
    ds_read_b64_tr_b16 a[182:183], v163 offset:8192
    v_cvt_pk_bf16_f32 v114, v116, v117
    v_mfma_f32_16x16x32_bf16 v[76:79], a[152:155], a[4:7], 0
    v_cvt_pk_bf16_f32 v115, v118, v119
    v_mfma_f32_16x16x32_bf16 v[76:79], a[156:159], a[16:19], v[76:79]
    ds_read_b64_tr_b16 a[186:187], v164 offset:8192
    ds_read_b64_tr_b16 a[190:191], v165 offset:8192
    v_fma_f32 v120, v120, s58, -v11
    v_mfma_f32_16x16x32_bf16 v[76:79], a[160:163], a[28:31], v[76:79]
    buffer_load_dwordx4 v20, s[28:31], s88 offen offset:3072 lds
    v_fma_f32 v121, v121, s58, -v11
    v_exp_f32 v120, v120
    v_mfma_f32_16x16x32_bf16 v[76:79], a[164:167], a[40:43], v[76:79]
    ds_read_b64_tr_b16 a[194:195], v166 offset:8192
    ds_read_b64_tr_b16 a[198:199], v167 offset:8192
    v_fma_f32 v122, v122, s58, -v11
    v_mfma_f32_16x16x32_bf16 v[84:87], a[152:155], a[8:11], 0
    v_exp_f32 v121, v121
    s_add_u32 m0, s43, 0
    v_mfma_f32_16x16x32_bf16 v[84:87], a[156:159], a[20:23], v[84:87]
    buffer_load_dwordx4 v17, s[28:31], s89 offen offset:0 lds
    v_fma_f32 v123, v123, s58, -v11
    v_mfma_f32_16x16x32_bf16 v[84:87], a[160:163], a[32:35], v[84:87]
    v_exp_f32 v122, v122
    v_mfma_f32_16x16x32_bf16 v[84:87], a[164:167], a[44:47], v[84:87]
    v_fma_f32 v124, v124, s58, -v11
    v_mfma_f32_16x16x32_bf16 v[180:183], a[132:135], v[88:91], v[180:183]
    buffer_load_dwordx4 v18, s[28:31], s89 offen offset:1024 lds
    v_exp_f32 v123, v123
    v_cvt_pk_bf16_f32 v120, v120, v121
    v_mfma_f32_16x16x32_bf16 v[184:187], a[132:135], v[96:99], v[184:187]
    v_fma_f32 v125, v125, s58, -v11
    v_mfma_f32_16x16x32_bf16 v[188:191], a[132:135], v[104:107], v[188:191]
    v_exp_f32 v124, v124
    s_waitcnt lgkmcnt(0)
    v_mfma_f32_16x16x32_bf16 v[40:43], a[168:171], v[88:91], v[40:43]
    buffer_load_dwordx4 v19, s[28:31], s89 offen offset:2048 lds
    v_fma_f32 v126, v126, s58, -v11
    v_mfma_f32_16x16x32_bf16 v[44:47], a[168:171], v[96:99], v[44:47]
    s_waitcnt vmcnt(19)
    ds_read_b128 a[136:139], v31 offset:24576
    ds_read_b128 a[140:143], v32 offset:24576
    v_exp_f32 v125, v125
    v_cvt_pk_bf16_f32 v121, v122, v123
    v_mfma_f32_16x16x32_bf16 v[48:51], a[168:171], v[104:107], v[48:51]
    v_fma_f32 v127, v127, s58, -v11
    v_mfma_f32_16x16x32_bf16 v[52:55], a[172:175], v[88:91], v[52:55]
    v_exp_f32 v126, v126
    v_mfma_f32_16x16x32_bf16 v[56:59], a[172:175], v[96:99], v[56:59]
    buffer_load_dwordx4 v20, s[28:31], s89 offen offset:3072 lds
    ds_read_b128 a[144:147], v33 offset:24576
    ds_read_b128 a[148:151], v34 offset:24576
    v_exp_f32 v127, v127
    v_mfma_f32_16x16x32_bf16 v[60:63], a[172:175], v[104:107], v[60:63]
    v_cvt_pk_bf16_f32 v122, v124, v125
    v_cvt_pk_bf16_f32 v123, v126, v127
    v_mfma_f32_16x16x32_bf16 a[48:51], a[176:179], v[88:91], a[48:51]
    v_fma_f32 v128, v128, s58, -v12
    s_add_u32 m0, s43, 28672
    v_mfma_f32_16x16x32_bf16 a[52:55], a[176:179], v[96:99], a[52:55]
    buffer_load_dwordx4 v21, s[32:35], s82 offen offset:0 lds
    v_fma_f32 v129, v129, s58, -v12
    v_mfma_f32_16x16x32_bf16 a[56:59], a[176:179], v[104:107], a[56:59]
    v_exp_f32 v128, v128
    v_mfma_f32_16x16x32_bf16 a[60:63], a[180:183], v[88:91], a[60:63]
    v_fma_f32 v130, v130, s58, -v12
    v_mfma_f32_16x16x32_bf16 a[64:67], a[180:183], v[96:99], a[64:67]
    buffer_load_dwordx4 v22, s[32:35], s82 offen offset:1024 lds
    v_exp_f32 v129, v129
L_pad2:
    s_cbranch_execz L_warm_ret
    s_nop 0
    v_fma_f32 v131, v131, s58, -v12
    v_mfma_f32_16x16x32_bf16 a[68:71], a[180:183], v[104:107], a[68:71]
    v_exp_f32 v130, v130
    v_mfma_f32_16x16x32_bf16 a[72:75], a[184:187], v[88:91], a[72:75]
    v_fma_f32 v132, v132, s58, -v12
    v_mfma_f32_16x16x32_bf16 a[76:79], a[184:187], v[96:99], a[76:79]
    buffer_load_dwordx4 v21, s[32:35], s82 offen offset:2048 lds
    v_exp_f32 v131, v131
    v_mfma_f32_16x16x32_bf16 a[80:83], a[184:187], v[104:107], a[80:83]
    s_waitcnt vmcnt(19)
    ds_read_b128 a[152:155], v31 offset:4096
    ds_read_b128 a[156:159], v32 offset:4096
    v_cvt_pk_bf16_f32 v128, v128, v129
    v_mfma_f32_16x16x32_bf16 a[84:87], a[188:191], v[88:91], a[84:87]
    v_fma_f32 v133, v133, s58, -v12
    v_mfma_f32_16x16x32_bf16 a[88:91], a[188:191], v[96:99], a[88:91]
    v_exp_f32 v132, v132
    v_mfma_f32_16x16x32_bf16 a[92:95], a[188:191], v[104:107], a[92:95]
    buffer_load_dwordx4 v22, s[32:35], s82 offen offset:3072 lds
    v_fma_f32 v134, v134, s58, -v12
    v_exp_f32 v133, v133
    v_mfma_f32_16x16x32_bf16 a[96:99], a[192:195], v[88:91], a[96:99]
    ds_read_b128 a[160:163], v33 offset:4096
    ds_read_b128 a[164:167], v34 offset:4096
    v_cvt_pk_bf16_f32 v129, v130, v131
    v_mfma_f32_16x16x32_bf16 a[100:103], a[192:195], v[96:99], a[100:103]
    v_fma_f32 v135, v135, s58, -v12
    v_mfma_f32_16x16x32_bf16 a[104:107], a[192:195], v[104:107], a[104:107]
    v_exp_f32 v134, v134
    s_add_u32 m0, s43, 32768
    v_mfma_f32_16x16x32_bf16 a[108:111], a[196:199], v[88:91], a[108:111]
    buffer_load_dwordx4 v21, s[32:35], s83 offen offset:0 lds
    v_exp_f32 v135, v135
    v_mfma_f32_16x16x32_bf16 a[112:115], a[196:199], v[96:99], a[112:115]
    v_cvt_pk_bf16_f32 v130, v132, v133
    v_mfma_f32_16x16x32_bf16 a[116:119], a[196:199], v[104:107], a[116:119]
    v_cvt_pk_bf16_f32 v131, v134, v135
    s_waitcnt lgkmcnt(1)
    v_mfma_f32_16x16x32_bf16 v[88:91], a[136:139], a[0:3], 0
    buffer_load_dwordx4 v22, s[32:35], s83 offen offset:1024 lds
    v_fma_f32 v136, v136, s58, -v10
    v_fma_f32 v137, v137, s58, -v10
    v_mfma_f32_16x16x32_bf16 v[88:91], a[140:143], a[12:15], v[88:91]
    s_waitcnt vmcnt(18)
    ds_read_b64_tr_b16 a[168:169], v160 offset:16384
    ds_read_b64_tr_b16 a[172:173], v161 offset:16384
    v_exp_f32 v136, v136
    v_mfma_f32_16x16x32_bf16 v[88:91], a[144:147], a[24:27], v[88:91]
    v_fma_f32 v138, v138, s58, -v10
    v_mfma_f32_16x16x32_bf16 v[88:91], a[148:151], a[36:39], v[88:91]
    buffer_load_dwordx4 v21, s[32:35], s83 offen offset:2048 lds
    ds_read_b64_tr_b16 a[176:177], v162 offset:16384
    ds_read_b64_tr_b16 a[180:181], v163 offset:16384
    v_exp_f32 v137, v137
    v_mfma_f32_16x16x32_bf16 v[96:99], a[136:139], a[4:7], 0
    v_fma_f32 v139, v139, s58, -v10
    v_mfma_f32_16x16x32_bf16 v[96:99], a[140:143], a[16:19], v[96:99]
    ds_read_b64_tr_b16 a[184:185], v164 offset:16384
    ds_read_b64_tr_b16 a[188:189], v165 offset:16384
    v_exp_f32 v138, v138
    v_mfma_f32_16x16x32_bf16 v[96:99], a[144:147], a[28:31], v[96:99]
    buffer_load_dwordx4 v22, s[32:35], s83 offen offset:3072 lds
    v_fma_f32 v140, v140, s58, -v10
    v_exp_f32 v139, v139
    v_mfma_f32_16x16x32_bf16 v[96:99], a[148:151], a[40:43], v[96:99]
    ds_read_b64_tr_b16 a[192:193], v166 offset:16384
    ds_read_b64_tr_b16 a[196:197], v167 offset:16384
    v_cvt_pk_bf16_f32 v136, v136, v137
    v_mfma_f32_16x16x32_bf16 v[104:107], a[136:139], a[8:11], 0
    v_fma_f32 v141, v141, s58, -v10
    s_add_u32 m0, s43, 12288
    v_mfma_f32_16x16x32_bf16 v[104:107], a[140:143], a[20:23], v[104:107]
    buffer_load_dwordx4 v17, s[28:31], s90 offen offset:0 lds
    v_exp_f32 v140, v140
    v_mfma_f32_16x16x32_bf16 v[104:107], a[144:147], a[32:35], v[104:107]
    v_fma_f32 v142, v142, s58, -v10
    v_mfma_f32_16x16x32_bf16 v[104:107], a[148:151], a[44:47], v[104:107]
    v_exp_f32 v141, v141
    v_mfma_f32_16x16x32_bf16 v[92:95], a[152:155], a[0:3], 0
    buffer_load_dwordx4 v18, s[28:31], s90 offen offset:1024 lds
    v_cvt_pk_bf16_f32 v137, v138, v139
    v_fma_f32 v143, v143, s58, -v10
    v_mfma_f32_16x16x32_bf16 v[92:95], a[156:159], a[12:15], v[92:95]
    s_waitcnt vmcnt(18)
    ds_read_b64_tr_b16 a[170:171], v160 offset:20480
    ds_read_b64_tr_b16 a[174:175], v161 offset:20480
    v_exp_f32 v142, v142
    v_mfma_f32_16x16x32_bf16 v[92:95], a[160:163], a[24:27], v[92:95]
    v_exp_f32 v143, v143
    s_waitcnt lgkmcnt(2)
    v_mfma_f32_16x16x32_bf16 v[92:95], a[164:167], a[36:39], v[92:95]
    buffer_load_dwordx4 v19, s[28:31], s90 offen offset:2048 lds
    ds_read_b64_tr_b16 a[178:179], v162 offset:20480
    ds_read_b64_tr_b16 a[182:183], v163 offset:20480
    v_cvt_pk_bf16_f32 v138, v140, v141
    v_mfma_f32_16x16x32_bf16 v[100:103], a[152:155], a[4:7], 0
    v_cvt_pk_bf16_f32 v139, v142, v143
    v_mfma_f32_16x16x32_bf16 v[100:103], a[156:159], a[16:19], v[100:103]
    ds_read_b64_tr_b16 a[186:187], v164 offset:20480
    ds_read_b64_tr_b16 a[190:191], v165 offset:20480
    v_fma_f32 v144, v144, s58, -v11
    v_mfma_f32_16x16x32_bf16 v[100:103], a[160:163], a[28:31], v[100:103]
    buffer_load_dwordx4 v20, s[28:31], s90 offen offset:3072 lds
    v_fma_f32 v145, v145, s58, -v11
    v_exp_f32 v144, v144
    v_mfma_f32_16x16x32_bf16 v[100:103], a[164:167], a[40:43], v[100:103]
    ds_read_b64_tr_b16 a[194:195], v166 offset:20480
    ds_read_b64_tr_b16 a[198:199], v167 offset:20480
    v_fma_f32 v146, v146, s58, -v11
    v_mfma_f32_16x16x32_bf16 v[108:111], a[152:155], a[8:11], 0
    v_exp_f32 v145, v145
    s_add_u32 m0, s43, 8192
    v_mfma_f32_16x16x32_bf16 v[108:111], a[156:159], a[20:23], v[108:111]
    buffer_load_dwordx4 v17, s[28:31], s91 offen offset:0 lds
    v_fma_f32 v147, v147, s58, -v11
    v_mfma_f32_16x16x32_bf16 v[108:111], a[160:163], a[32:35], v[108:111]
    v_exp_f32 v146, v146
    v_mfma_f32_16x16x32_bf16 v[108:111], a[164:167], a[44:47], v[108:111]
    v_fma_f32 v148, v148, s58, -v11
    v_mfma_f32_16x16x32_bf16 v[180:183], a[132:135], v[112:115], v[180:183]
    buffer_load_dwordx4 v18, s[28:31], s91 offen offset:1024 lds
    v_exp_f32 v147, v147
    v_cvt_pk_bf16_f32 v144, v144, v145
    v_mfma_f32_16x16x32_bf16 v[184:187], a[132:135], v[120:123], v[184:187]
    v_fma_f32 v149, v149, s58, -v11
    v_mfma_f32_16x16x32_bf16 v[188:191], a[132:135], v[128:131], v[188:191]
    v_exp_f32 v148, v148
    s_waitcnt lgkmcnt(0)
    v_mfma_f32_16x16x32_bf16 v[40:43], a[168:171], v[112:115], v[40:43]
    buffer_load_dwordx4 v19, s[28:31], s91 offen offset:2048 lds
    v_fma_f32 v150, v150, s58, -v11
    v_mfma_f32_16x16x32_bf16 v[44:47], a[168:171], v[120:123], v[44:47]
    s_waitcnt vmcnt(19)
    ds_read_b128 a[136:139], v31 offset:36864
    ds_read_b128 a[140:143], v32 offset:36864
    v_exp_f32 v149, v149
    v_cvt_pk_bf16_f32 v145, v146, v147
    v_mfma_f32_16x16x32_bf16 v[48:51], a[168:171], v[128:131], v[48:51]
    v_fma_f32 v151, v151, s58, -v11
    v_mfma_f32_16x16x32_bf16 v[52:55], a[172:175], v[112:115], v[52:55]
    v_exp_f32 v150, v150
    v_mfma_f32_16x16x32_bf16 v[56:59], a[172:175], v[120:123], v[56:59]
    buffer_load_dwordx4 v20, s[28:31], s91 offen offset:3072 lds
    ds_read_b128 a[144:147], v33 offset:36864
    ds_read_b128 a[148:151], v34 offset:36864
    v_exp_f32 v151, v151
    v_mfma_f32_16x16x32_bf16 v[60:63], a[172:175], v[128:131], v[60:63]
    v_cvt_pk_bf16_f32 v146, v148, v149
    v_cvt_pk_bf16_f32 v147, v150, v151
    v_mfma_f32_16x16x32_bf16 a[48:51], a[176:179], v[112:115], a[48:51]
    v_fma_f32 v152, v152, s58, -v12
    s_add_u32 m0, s43, 24576
    v_mfma_f32_16x16x32_bf16 a[52:55], a[176:179], v[120:123], a[52:55]
    buffer_load_dwordx4 v21, s[32:35], s84 offen offset:0 lds
    v_fma_f32 v153, v153, s58, -v12
    v_mfma_f32_16x16x32_bf16 a[56:59], a[176:179], v[128:131], a[56:59]
    v_exp_f32 v152, v152
    v_mfma_f32_16x16x32_bf16 a[60:63], a[180:183], v[112:115], a[60:63]
    v_fma_f32 v154, v154, s58, -v12
    v_mfma_f32_16x16x32_bf16 a[64:67], a[180:183], v[120:123], a[64:67]
    buffer_load_dwordx4 v22, s[32:35], s84 offen offset:1024 lds
    v_exp_f32 v153, v153
    v_fma_f32 v155, v155, s58, -v12
    v_mfma_f32_16x16x32_bf16 a[68:71], a[180:183], v[128:131], a[68:71]
    v_exp_f32 v154, v154
    v_mfma_f32_16x16x32_bf16 a[72:75], a[184:187], v[112:115], a[72:75]
    v_fma_f32 v156, v156, s58, -v12
    v_mfma_f32_16x16x32_bf16 a[76:79], a[184:187], v[120:123], a[76:79]
    buffer_load_dwordx4 v21, s[32:35], s84 offen offset:2048 lds
    v_exp_f32 v155, v155
    v_mfma_f32_16x16x32_bf16 a[80:83], a[184:187], v[128:131], a[80:83]
    s_waitcnt vmcnt(19)
    ds_read_b128 a[152:155], v31 offset:0
    ds_read_b128 a[156:159], v32 offset:0
    v_cvt_pk_bf16_f32 v152, v152, v153
    v_mfma_f32_16x16x32_bf16 a[84:87], a[188:191], v[112:115], a[84:87]
    v_fma_f32 v157, v157, s58, -v12
    v_mfma_f32_16x16x32_bf16 a[88:91], a[188:191], v[120:123], a[88:91]
    v_exp_f32 v156, v156
    v_mfma_f32_16x16x32_bf16 a[92:95], a[188:191], v[128:131], a[92:95]
    buffer_load_dwordx4 v22, s[32:35], s84 offen offset:3072 lds
    v_fma_f32 v158, v158, s58, -v12
    v_exp_f32 v157, v157
    v_mfma_f32_16x16x32_bf16 a[96:99], a[192:195], v[112:115], a[96:99]
    ds_read_b128 a[160:163], v33 offset:0
    ds_read_b128 a[164:167], v34 offset:0
    v_cvt_pk_bf16_f32 v153, v154, v155
    v_mfma_f32_16x16x32_bf16 a[100:103], a[192:195], v[120:123], a[100:103]
    v_fma_f32 v159, v159, s58, -v12
    v_mfma_f32_16x16x32_bf16 a[104:107], a[192:195], v[128:131], a[104:107]
    v_exp_f32 v158, v158
    s_add_u32 m0, s43, 4096
    v_mfma_f32_16x16x32_bf16 a[108:111], a[196:199], v[112:115], a[108:111]
    buffer_load_dwordx4 v21, s[32:35], s85 offen offset:0 lds
    v_exp_f32 v159, v159
    v_mfma_f32_16x16x32_bf16 a[112:115], a[196:199], v[120:123], a[112:115]
    v_cvt_pk_bf16_f32 v154, v156, v157
    v_mfma_f32_16x16x32_bf16 a[116:119], a[196:199], v[128:131], a[116:119]
    v_cvt_pk_bf16_f32 v155, v158, v159
    s_waitcnt lgkmcnt(1)
    v_mfma_f32_16x16x32_bf16 v[112:115], a[136:139], a[0:3], 0
    buffer_load_dwordx4 v22, s[32:35], s85 offen offset:1024 lds
    v_fma_f32 v64, v64, s58, -v10
    v_fma_f32 v65, v65, s58, -v10
    v_mfma_f32_16x16x32_bf16 v[112:115], a[140:143], a[12:15], v[112:115]
    s_waitcnt vmcnt(18)
    ds_read_b64_tr_b16 a[168:169], v160 offset:28672
    ds_read_b64_tr_b16 a[172:173], v161 offset:28672
    v_exp_f32 v64, v64
    v_mfma_f32_16x16x32_bf16 v[112:115], a[144:147], a[24:27], v[112:115]
    v_fma_f32 v66, v66, s58, -v10
    v_mfma_f32_16x16x32_bf16 v[112:115], a[148:151], a[36:39], v[112:115]
    buffer_load_dwordx4 v21, s[32:35], s85 offen offset:2048 lds
    ds_read_b64_tr_b16 a[176:177], v162 offset:28672
    ds_read_b64_tr_b16 a[180:181], v163 offset:28672
    v_exp_f32 v65, v65
    v_mfma_f32_16x16x32_bf16 v[120:123], a[136:139], a[4:7], 0
    v_fma_f32 v67, v67, s58, -v10
    v_mfma_f32_16x16x32_bf16 v[120:123], a[140:143], a[16:19], v[120:123]
    ds_read_b64_tr_b16 a[184:185], v164 offset:28672
    ds_read_b64_tr_b16 a[188:189], v165 offset:28672
    v_exp_f32 v66, v66
    v_mfma_f32_16x16x32_bf16 v[120:123], a[144:147], a[28:31], v[120:123]
    buffer_load_dwordx4 v22, s[32:35], s85 offen offset:3072 lds
    v_fma_f32 v68, v68, s58, -v10
    v_exp_f32 v67, v67
    v_mfma_f32_16x16x32_bf16 v[120:123], a[148:151], a[40:43], v[120:123]
    ds_read_b64_tr_b16 a[192:193], v166 offset:28672
    ds_read_b64_tr_b16 a[196:197], v167 offset:28672
    v_cvt_pk_bf16_f32 v64, v64, v65
    v_mfma_f32_16x16x32_bf16 v[128:131], a[136:139], a[8:11], 0
    v_fma_f32 v69, v69, s58, -v10
    s_add_u32 m0, s43, 16384
    v_mfma_f32_16x16x32_bf16 v[128:131], a[140:143], a[20:23], v[128:131]
    buffer_load_dwordx4 v21, s[32:35], s86 offen offset:0 lds
    v_exp_f32 v68, v68
    v_mfma_f32_16x16x32_bf16 v[128:131], a[144:147], a[32:35], v[128:131]
    v_fma_f32 v70, v70, s58, -v10
    v_mfma_f32_16x16x32_bf16 v[128:131], a[148:151], a[44:47], v[128:131]
    v_exp_f32 v69, v69
    v_mfma_f32_16x16x32_bf16 v[116:119], a[152:155], a[0:3], 0
    buffer_load_dwordx4 v22, s[32:35], s86 offen offset:1024 lds
    v_cvt_pk_bf16_f32 v65, v66, v67
    v_fma_f32 v71, v71, s58, -v10
    v_mfma_f32_16x16x32_bf16 v[116:119], a[156:159], a[12:15], v[116:119]
    s_waitcnt vmcnt(18)
    ds_read_b64_tr_b16 a[170:171], v160 offset:32768
    ds_read_b64_tr_b16 a[174:175], v161 offset:32768
    v_exp_f32 v70, v70
    v_mfma_f32_16x16x32_bf16 v[116:119], a[160:163], a[24:27], v[116:119]
    v_exp_f32 v71, v71
    s_waitcnt lgkmcnt(2)
    v_mfma_f32_16x16x32_bf16 v[116:119], a[164:167], a[36:39], v[116:119]
    buffer_load_dwordx4 v21, s[32:35], s86 offen offset:2048 lds
    ds_read_b64_tr_b16 a[178:179], v162 offset:32768
    ds_read_b64_tr_b16 a[182:183], v163 offset:32768
    v_cvt_pk_bf16_f32 v66, v68, v69
    v_mfma_f32_16x16x32_bf16 v[124:127], a[152:155], a[4:7], 0
    v_cvt_pk_bf16_f32 v67, v70, v71
    v_mfma_f32_16x16x32_bf16 v[124:127], a[156:159], a[16:19], v[124:127]
    ds_read_b64_tr_b16 a[186:187], v164 offset:32768
    ds_read_b64_tr_b16 a[190:191], v165 offset:32768
    v_fma_f32 v72, v72, s58, -v11
    v_mfma_f32_16x16x32_bf16 v[124:127], a[160:163], a[28:31], v[124:127]
    buffer_load_dwordx4 v22, s[32:35], s86 offen offset:3072 lds
    v_fma_f32 v73, v73, s58, -v11
    v_exp_f32 v72, v72
    v_mfma_f32_16x16x32_bf16 v[124:127], a[164:167], a[40:43], v[124:127]
    ds_read_b64_tr_b16 a[194:195], v166 offset:32768
    ds_read_b64_tr_b16 a[198:199], v167 offset:32768
    v_fma_f32 v74, v74, s58, -v11
    v_mfma_f32_16x16x32_bf16 v[132:135], a[152:155], a[8:11], 0
    v_exp_f32 v73, v73
    s_add_u32 m0, s43, 20480
    v_mfma_f32_16x16x32_bf16 v[132:135], a[156:159], a[20:23], v[132:135]
    buffer_load_dwordx4 v21, s[32:35], s87 offen offset:0 lds
    v_fma_f32 v75, v75, s58, -v11
    v_mfma_f32_16x16x32_bf16 v[132:135], a[160:163], a[32:35], v[132:135]
    v_exp_f32 v74, v74
    v_mfma_f32_16x16x32_bf16 v[132:135], a[164:167], a[44:47], v[132:135]
    v_fma_f32 v76, v76, s58, -v11
    v_mfma_f32_16x16x32_bf16 v[180:183], a[132:135], v[136:139], v[180:183]
    buffer_load_dwordx4 v22, s[32:35], s87 offen offset:1024 lds
    v_exp_f32 v75, v75
    v_cvt_pk_bf16_f32 v72, v72, v73
    v_mfma_f32_16x16x32_bf16 v[184:187], a[132:135], v[144:147], v[184:187]
    v_fma_f32 v77, v77, s58, -v11
    v_mfma_f32_16x16x32_bf16 v[188:191], a[132:135], v[152:155], v[188:191]
    v_exp_f32 v76, v76
    s_waitcnt lgkmcnt(0)
    v_mfma_f32_16x16x32_bf16 v[40:43], a[168:171], v[136:139], v[40:43]
    buffer_load_dwordx4 v21, s[32:35], s87 offen offset:2048 lds
    v_fma_f32 v78, v78, s58, -v11
    v_mfma_f32_16x16x32_bf16 v[44:47], a[168:171], v[144:147], v[44:47]
    s_waitcnt vmcnt(19)
    ds_read_b128 a[136:139], v31 offset:12288
    ds_read_b128 a[140:143], v32 offset:12288
    v_exp_f32 v77, v77
    v_cvt_pk_bf16_f32 v73, v74, v75
    v_mfma_f32_16x16x32_bf16 v[48:51], a[168:171], v[152:155], v[48:51]
    v_fma_f32 v79, v79, s58, -v11
    v_mfma_f32_16x16x32_bf16 v[52:55], a[172:175], v[136:139], v[52:55]
    v_exp_f32 v78, v78
    v_mfma_f32_16x16x32_bf16 v[56:59], a[172:175], v[144:147], v[56:59]
    buffer_load_dwordx4 v22, s[32:35], s87 offen offset:3072 lds
    ds_read_b128 a[144:147], v33 offset:12288
    ds_read_b128 a[148:151], v34 offset:12288
    v_exp_f32 v79, v79
    v_mfma_f32_16x16x32_bf16 v[60:63], a[172:175], v[152:155], v[60:63]
    v_cvt_pk_bf16_f32 v74, v76, v77
    v_cvt_pk_bf16_f32 v75, v78, v79
    v_mfma_f32_16x16x32_bf16 a[48:51], a[176:179], v[136:139], a[48:51]
    v_fma_f32 v80, v80, s58, -v12
    s_add_u32 m0, s43, 36864
    v_mfma_f32_16x16x32_bf16 a[52:55], a[176:179], v[144:147], a[52:55]
    buffer_load_dwordx4 v21, s[32:35], s88 offen offset:0 lds
    v_fma_f32 v81, v81, s58, -v12
    v_mfma_f32_16x16x32_bf16 a[56:59], a[176:179], v[152:155], a[56:59]
    v_exp_f32 v80, v80
    v_mfma_f32_16x16x32_bf16 a[60:63], a[180:183], v[136:139], a[60:63]
    v_fma_f32 v82, v82, s58, -v12
    v_mfma_f32_16x16x32_bf16 a[64:67], a[180:183], v[144:147], a[64:67]
    buffer_load_dwordx4 v22, s[32:35], s88 offen offset:1024 lds
    v_exp_f32 v81, v81
    v_fma_f32 v83, v83, s58, -v12
    v_mfma_f32_16x16x32_bf16 a[68:71], a[180:183], v[152:155], a[68:71]
    v_exp_f32 v82, v82
    v_mfma_f32_16x16x32_bf16 a[72:75], a[184:187], v[136:139], a[72:75]
    v_fma_f32 v84, v84, s58, -v12
    v_mfma_f32_16x16x32_bf16 a[76:79], a[184:187], v[144:147], a[76:79]
    buffer_load_dwordx4 v21, s[32:35], s88 offen offset:2048 lds
    v_exp_f32 v83, v83
    v_mfma_f32_16x16x32_bf16 a[80:83], a[184:187], v[152:155], a[80:83]
    s_waitcnt vmcnt(19)
    ds_read_b128 a[152:155], v31 offset:8192
    ds_read_b128 a[156:159], v32 offset:8192
    v_cvt_pk_bf16_f32 v80, v80, v81
    v_mfma_f32_16x16x32_bf16 a[84:87], a[188:191], v[136:139], a[84:87]
    v_fma_f32 v85, v85, s58, -v12
    v_mfma_f32_16x16x32_bf16 a[88:91], a[188:191], v[144:147], a[88:91]
    v_exp_f32 v84, v84
    v_mfma_f32_16x16x32_bf16 a[92:95], a[188:191], v[152:155], a[92:95]
    buffer_load_dwordx4 v22, s[32:35], s88 offen offset:3072 lds
    v_fma_f32 v86, v86, s58, -v12
    v_exp_f32 v85, v85
    v_mfma_f32_16x16x32_bf16 a[96:99], a[192:195], v[136:139], a[96:99]
    ds_read_b128 a[160:163], v33 offset:8192
    ds_read_b128 a[164:167], v34 offset:8192
    v_cvt_pk_bf16_f32 v81, v82, v83
    v_mfma_f32_16x16x32_bf16 a[100:103], a[192:195], v[144:147], a[100:103]
    v_fma_f32 v87, v87, s58, -v12
    v_mfma_f32_16x16x32_bf16 a[104:107], a[192:195], v[152:155], a[104:107]
    v_exp_f32 v86, v86
    s_add_u32 m0, s43, 0
    v_mfma_f32_16x16x32_bf16 a[108:111], a[196:199], v[136:139], a[108:111]
    buffer_load_dwordx4 v21, s[32:35], s89 offen offset:0 lds
    v_exp_f32 v87, v87
    v_mfma_f32_16x16x32_bf16 a[112:115], a[196:199], v[144:147], a[112:115]
    v_cvt_pk_bf16_f32 v82, v84, v85
    v_mfma_f32_16x16x32_bf16 a[116:119], a[196:199], v[152:155], a[116:119]
    v_cvt_pk_bf16_f32 v83, v86, v87
    s_waitcnt lgkmcnt(1)
    v_mfma_f32_16x16x32_bf16 v[136:139], a[136:139], a[0:3], 0
    buffer_load_dwordx4 v22, s[32:35], s89 offen offset:1024 lds
    v_fma_f32 v88, v88, s58, -v10
    v_fma_f32 v89, v89, s58, -v10
    v_mfma_f32_16x16x32_bf16 v[136:139], a[140:143], a[12:15], v[136:139]
    s_waitcnt vmcnt(18)
    ds_read_b64_tr_b16 a[168:169], v160 offset:24576
    ds_read_b64_tr_b16 a[172:173], v161 offset:24576
    v_exp_f32 v88, v88
    v_mfma_f32_16x16x32_bf16 v[136:139], a[144:147], a[24:27], v[136:139]
    v_fma_f32 v90, v90, s58, -v10
    v_mfma_f32_16x16x32_bf16 v[136:139], a[148:151], a[36:39], v[136:139]
    buffer_load_dwordx4 v21, s[32:35], s89 offen offset:2048 lds
    ds_read_b64_tr_b16 a[176:177], v162 offset:24576
    ds_read_b64_tr_b16 a[180:181], v163 offset:24576
    v_exp_f32 v89, v89
    v_mfma_f32_16x16x32_bf16 v[144:147], a[136:139], a[4:7], 0
    v_fma_f32 v91, v91, s58, -v10
    v_mfma_f32_16x16x32_bf16 v[144:147], a[140:143], a[16:19], v[144:147]
    ds_read_b64_tr_b16 a[184:185], v164 offset:24576
    ds_read_b64_tr_b16 a[188:189], v165 offset:24576
    v_exp_f32 v90, v90
    v_mfma_f32_16x16x32_bf16 v[144:147], a[144:147], a[28:31], v[144:147]
    buffer_load_dwordx4 v22, s[32:35], s89 offen offset:3072 lds
    v_fma_f32 v92, v92, s58, -v10
    v_exp_f32 v91, v91
    v_mfma_f32_16x16x32_bf16 v[144:147], a[148:151], a[40:43], v[144:147]
    ds_read_b64_tr_b16 a[192:193], v166 offset:24576
    ds_read_b64_tr_b16 a[196:197], v167 offset:24576
    v_cvt_pk_bf16_f32 v88, v88, v89
    v_mfma_f32_16x16x32_bf16 v[152:155], a[136:139], a[8:11], 0
    v_fma_f32 v93, v93, s58, -v10
    s_add_u32 m0, s43, 28672
    v_mfma_f32_16x16x32_bf16 v[152:155], a[140:143], a[20:23], v[152:155]
    buffer_load_dwordx4 v21, s[32:35], s90 offen offset:0 lds
    v_exp_f32 v92, v92
    v_mfma_f32_16x16x32_bf16 v[152:155], a[144:147], a[32:35], v[152:155]
    v_fma_f32 v94, v94, s58, -v10
    v_mfma_f32_16x16x32_bf16 v[152:155], a[148:151], a[44:47], v[152:155]
    v_exp_f32 v93, v93
    v_mfma_f32_16x16x32_bf16 v[140:143], a[152:155], a[0:3], 0
    buffer_load_dwordx4 v22, s[32:35], s90 offen offset:1024 lds
    v_cvt_pk_bf16_f32 v89, v90, v91
    v_fma_f32 v95, v95, s58, -v10
    v_mfma_f32_16x16x32_bf16 v[140:143], a[156:159], a[12:15], v[140:143]
    s_waitcnt vmcnt(18)
    ds_read_b64_tr_b16 a[170:171], v160 offset:4096
    ds_read_b64_tr_b16 a[174:175], v161 offset:4096
    v_exp_f32 v94, v94
    v_mfma_f32_16x16x32_bf16 v[140:143], a[160:163], a[24:27], v[140:143]
    v_exp_f32 v95, v95
    s_waitcnt lgkmcnt(2)
    v_mfma_f32_16x16x32_bf16 v[140:143], a[164:167], a[36:39], v[140:143]
    buffer_load_dwordx4 v21, s[32:35], s90 offen offset:2048 lds
    ds_read_b64_tr_b16 a[178:179], v162 offset:4096
    ds_read_b64_tr_b16 a[182:183], v163 offset:4096
    v_cvt_pk_bf16_f32 v90, v92, v93
    v_mfma_f32_16x16x32_bf16 v[148:151], a[152:155], a[4:7], 0
    v_cvt_pk_bf16_f32 v91, v94, v95
    v_mfma_f32_16x16x32_bf16 v[148:151], a[156:159], a[16:19], v[148:151]
    ds_read_b64_tr_b16 a[186:187], v164 offset:4096
    ds_read_b64_tr_b16 a[190:191], v165 offset:4096
    v_fma_f32 v96, v96, s58, -v11
    v_mfma_f32_16x16x32_bf16 v[148:151], a[160:163], a[28:31], v[148:151]
    buffer_load_dwordx4 v22, s[32:35], s90 offen offset:3072 lds
    v_fma_f32 v97, v97, s58, -v11
    v_exp_f32 v96, v96
    v_mfma_f32_16x16x32_bf16 v[148:151], a[164:167], a[40:43], v[148:151]
    ds_read_b64_tr_b16 a[194:195], v166 offset:4096
    ds_read_b64_tr_b16 a[198:199], v167 offset:4096
    v_fma_f32 v98, v98, s58, -v11
    v_mfma_f32_16x16x32_bf16 v[156:159], a[152:155], a[8:11], 0
    v_exp_f32 v97, v97
    s_add_u32 m0, s43, 32768
    v_mfma_f32_16x16x32_bf16 v[156:159], a[156:159], a[20:23], v[156:159]
    buffer_load_dwordx4 v21, s[32:35], s91 offen offset:0 lds
    v_fma_f32 v99, v99, s58, -v11
    v_mfma_f32_16x16x32_bf16 v[156:159], a[160:163], a[32:35], v[156:159]
    v_exp_f32 v98, v98
    v_mfma_f32_16x16x32_bf16 v[156:159], a[164:167], a[44:47], v[156:159]
    v_fma_f32 v100, v100, s58, -v11
    v_mfma_f32_16x16x32_bf16 v[180:183], a[132:135], v[64:67], v[180:183]
    buffer_load_dwordx4 v22, s[32:35], s91 offen offset:1024 lds
    v_exp_f32 v99, v99
    v_cvt_pk_bf16_f32 v96, v96, v97
    v_mfma_f32_16x16x32_bf16 v[184:187], a[132:135], v[72:75], v[184:187]
    v_fma_f32 v101, v101, s58, -v11
    v_mfma_f32_16x16x32_bf16 v[188:191], a[132:135], v[80:83], v[188:191]
    v_exp_f32 v100, v100
    s_waitcnt lgkmcnt(0)
    v_mfma_f32_16x16x32_bf16 v[40:43], a[168:171], v[64:67], v[40:43]
    buffer_load_dwordx4 v21, s[32:35], s91 offen offset:2048 lds
    v_fma_f32 v102, v102, s58, -v11
    v_mfma_f32_16x16x32_bf16 v[44:47], a[168:171], v[72:75], v[44:47]
    v_exp_f32 v101, v101
    v_cvt_pk_bf16_f32 v97, v98, v99
    v_mfma_f32_16x16x32_bf16 v[48:51], a[168:171], v[80:83], v[48:51]
    v_fma_f32 v103, v103, s58, -v11
    v_mfma_f32_16x16x32_bf16 v[52:55], a[172:175], v[64:67], v[52:55]
    v_exp_f32 v102, v102
    v_mfma_f32_16x16x32_bf16 v[56:59], a[172:175], v[72:75], v[56:59]
    buffer_load_dwordx4 v22, s[32:35], s91 offen offset:3072 lds
    v_exp_f32 v103, v103
    v_mfma_f32_16x16x32_bf16 v[60:63], a[172:175], v[80:83], v[60:63]
    v_cvt_pk_bf16_f32 v98, v100, v101
    v_cvt_pk_bf16_f32 v99, v102, v103
    v_mfma_f32_16x16x32_bf16 a[48:51], a[176:179], v[64:67], a[48:51]
    v_fma_f32 v104, v104, s58, -v12
    v_mfma_f32_16x16x32_bf16 a[52:55], a[176:179], v[72:75], a[52:55]
    s_add_u32 m0, s43, 12288
    s_bfe_u32 s57, s56, 0x40000
    s_lshl_b32 s57, s57, 18
    buffer_load_dwordx4 v168, s[60:63], s57 offen offset:0 lds
    v_fma_f32 v105, v105, s58, -v12
    v_mfma_f32_16x16x32_bf16 a[56:59], a[176:179], v[80:83], a[56:59]
    v_exp_f32 v104, v104
    v_mfma_f32_16x16x32_bf16 a[60:63], a[180:183], v[64:67], a[60:63]
    v_fma_f32 v106, v106, s58, -v12
    v_mfma_f32_16x16x32_bf16 a[64:67], a[180:183], v[72:75], a[64:67]
    buffer_load_dwordx4 v169, s[60:63], s57 offen offset:1024 lds
    v_exp_f32 v105, v105
    v_fma_f32 v107, v107, s58, -v12
    v_mfma_f32_16x16x32_bf16 a[68:71], a[180:183], v[80:83], a[68:71]
    s_waitcnt vmcnt(18)
    ds_read_b64_tr_b16 a[136:137], v160 offset:16384
    ds_read_b64_tr_b16 a[138:139], v160 offset:20480
    v_exp_f32 v106, v106
    v_mfma_f32_16x16x32_bf16 a[72:75], a[184:187], v[64:67], a[72:75]
    ds_read_b64_tr_b16 a[140:141], v161 offset:16384
    ds_read_b64_tr_b16 a[142:143], v161 offset:20480
    v_fma_f32 v108, v108, s58, -v12
    v_mfma_f32_16x16x32_bf16 a[76:79], a[184:187], v[72:75], a[76:79]
    buffer_load_dwordx4 v170, s[60:63], s57 offen offset:2048 lds
    ds_read_b64_tr_b16 a[144:145], v162 offset:16384
    ds_read_b64_tr_b16 a[146:147], v162 offset:20480
    v_exp_f32 v107, v107
    v_mfma_f32_16x16x32_bf16 a[80:83], a[184:187], v[80:83], a[80:83]
    v_cvt_pk_bf16_f32 v104, v104, v105
    v_mfma_f32_16x16x32_bf16 a[84:87], a[188:191], v[64:67], a[84:87]
    ds_read_b64_tr_b16 a[148:149], v163 offset:16384
    ds_read_b64_tr_b16 a[150:151], v163 offset:20480
    v_fma_f32 v109, v109, s58, -v12
    v_mfma_f32_16x16x32_bf16 a[88:91], a[188:191], v[72:75], a[88:91]
    buffer_load_dwordx4 v171, s[60:63], s57 offen offset:3072 lds
    ds_read_b64_tr_b16 a[152:153], v164 offset:16384
    ds_read_b64_tr_b16 a[154:155], v164 offset:20480
    v_exp_f32 v108, v108
    v_mfma_f32_16x16x32_bf16 a[92:95], a[188:191], v[80:83], a[92:95]
    ds_read_b64_tr_b16 a[156:157], v165 offset:16384
    ds_read_b64_tr_b16 a[158:159], v165 offset:20480
    v_fma_f32 v110, v110, s58, -v12
    v_exp_f32 v109, v109
    v_mfma_f32_16x16x32_bf16 a[96:99], a[192:195], v[64:67], a[96:99]
    v_cvt_pk_bf16_f32 v105, v106, v107
    v_mfma_f32_16x16x32_bf16 a[100:103], a[192:195], v[72:75], a[100:103]
    buffer_load_dword v251, v13, s[64:67], s5 offen sc1
    ds_read_b64_tr_b16 a[160:161], v166 offset:16384
    ds_read_b64_tr_b16 a[162:163], v166 offset:20480
    v_fma_f32 v111, v111, s58, -v12
    v_mfma_f32_16x16x32_bf16 a[104:107], a[192:195], v[80:83], a[104:107]
    ds_read_b64_tr_b16 a[164:165], v167 offset:16384
    ds_read_b64_tr_b16 a[166:167], v167 offset:20480
    v_exp_f32 v110, v110
    v_mfma_f32_16x16x32_bf16 a[108:111], a[196:199], v[64:67], a[108:111]
    v_exp_f32 v111, v111
    v_mfma_f32_16x16x32_bf16 a[112:115], a[196:199], v[72:75], a[112:115]
    buffer_load_dword v249, v14, s[64:67], s4 offen offset:256 sc1
    v_cvt_pk_bf16_f32 v106, v108, v109
    v_mfma_f32_16x16x32_bf16 a[116:119], a[196:199], v[80:83], a[116:119]
    v_cvt_pk_bf16_f32 v107, v110, v111
    v_mfma_f32_16x16x32_bf16 v[180:183], a[132:135], v[88:91], v[180:183]
    s_add_u32 m0, s43, 8192
    s_bfe_u32 s57, s56, 0x40004
    s_lshl_b32 s57, s57, 18
    buffer_load_dwordx4 v168, s[60:63], s57 offen offset:0 lds
    v_fma_f32 v112, v112, s58, -v10
    v_fma_f32 v113, v113, s58, -v10
    v_exp_f32 v112, v112
    v_fma_f32 v114, v114, s58, -v10
    v_exp_f32 v113, v113
    v_mfma_f32_16x16x32_bf16 v[184:187], a[132:135], v[96:99], v[184:187]
    buffer_load_dwordx4 v169, s[60:63], s57 offen offset:1024 lds
    v_fma_f32 v115, v115, s58, -v10
    v_exp_f32 v114, v114
    v_fma_f32 v116, v116, s58, -v10
    v_exp_f32 v115, v115
    v_mfma_f32_16x16x32_bf16 v[188:191], a[132:135], v[104:107], v[188:191]
    buffer_load_dwordx4 v170, s[60:63], s57 offen offset:2048 lds
    s_waitcnt vmcnt(17)
    ds_read_b64_tr_b16 a[176:177], v162 offset:36864
    ds_read_b64_tr_b16 a[178:179], v162 offset:0
    v_cvt_pk_bf16_f32 v112, v112, v113
    v_fma_f32 v117, v117, s58, -v10
    v_exp_f32 v116, v116
    v_fma_f32 v118, v118, s58, -v10
    s_waitcnt lgkmcnt(2)
    v_mfma_f32_16x16x32_bf16 v[40:43], a[136:139], v[88:91], v[40:43]
    buffer_load_dwordx4 v171, s[60:63], s57 offen offset:3072 lds
    ds_read_b64_tr_b16 a[180:181], v163 offset:36864
    ds_read_b64_tr_b16 a[182:183], v163 offset:0
    v_exp_f32 v117, v117
    v_cvt_pk_bf16_f32 v113, v114, v115
    v_fma_f32 v119, v119, s58, -v10
    v_exp_f32 v118, v118
    v_exp_f32 v119, v119
L_pad3:
    s_cbranch_execz L_warm_ret
    s_nop 0
    v_mfma_f32_16x16x32_bf16 v[44:47], a[136:139], v[96:99], v[44:47]
    ds_read_b64_tr_b16 a[184:185], v164 offset:36864
    ds_read_b64_tr_b16 a[186:187], v164 offset:0
    v_cvt_pk_bf16_f32 v114, v116, v117
    v_cvt_pk_bf16_f32 v115, v118, v119
    v_fma_f32 v120, v120, s58, -v11
    v_fma_f32 v121, v121, s58, -v11
    v_mfma_f32_16x16x32_bf16 v[48:51], a[136:139], v[104:107], v[48:51]
    v_exp_f32 v120, v120
    v_fma_f32 v122, v122, s58, -v11
    v_exp_f32 v121, v121
    v_fma_f32 v123, v123, s58, -v11
    v_mfma_f32_16x16x32_bf16 v[52:55], a[140:143], v[88:91], v[52:55]
    ds_read_b64_tr_b16 a[188:189], v165 offset:36864
    ds_read_b64_tr_b16 a[190:191], v165 offset:0
    v_exp_f32 v122, v122
    v_fma_f32 v124, v124, s58, -v11
    v_exp_f32 v123, v123
    v_cvt_pk_bf16_f32 v120, v120, v121
    v_mfma_f32_16x16x32_bf16 v[56:59], a[140:143], v[96:99], v[56:59]
    ds_read_b64_tr_b16 a[192:193], v166 offset:36864
    ds_read_b64_tr_b16 a[194:195], v166 offset:0
    v_fma_f32 v125, v125, s58, -v11
    v_exp_f32 v124, v124
    v_fma_f32 v126, v126, s58, -v11
    v_exp_f32 v125, v125
    v_cvt_pk_bf16_f32 v121, v122, v123
    v_mfma_f32_16x16x32_bf16 v[60:63], a[140:143], v[104:107], v[60:63]
    ds_read_b64_tr_b16 a[196:197], v167 offset:36864
    ds_read_b64_tr_b16 a[198:199], v167 offset:0
    v_fma_f32 v127, v127, s58, -v11
    v_exp_f32 v126, v126
    v_exp_f32 v127, v127
    v_cvt_pk_bf16_f32 v122, v124, v125
    v_mfma_f32_16x16x32_bf16 a[48:51], a[144:147], v[88:91], a[48:51]
    v_cvt_pk_bf16_f32 v123, v126, v127
    v_fma_f32 v128, v128, s58, -v12
    v_fma_f32 v129, v129, s58, -v12
    v_exp_f32 v128, v128
    v_mfma_f32_16x16x32_bf16 a[52:55], a[144:147], v[96:99], a[52:55]
    ds_read_b64_tr_b16 a[168:169], v160 offset:36864
    ds_read_b64_tr_b16 a[170:171], v160 offset:0
    v_fma_f32 v130, v130, s58, -v12
    v_exp_f32 v129, v129
    v_fma_f32 v131, v131, s58, -v12
    v_exp_f32 v130, v130
    v_fma_f32 v132, v132, s58, -v12
    v_mfma_f32_16x16x32_bf16 a[56:59], a[144:147], v[104:107], a[56:59]
    ds_read_b64_tr_b16 a[172:173], v161 offset:36864
    ds_read_b64_tr_b16 a[174:175], v161 offset:0
    v_exp_f32 v131, v131
    v_cvt_pk_bf16_f32 v128, v128, v129
    v_fma_f32 v133, v133, s58, -v12
    v_exp_f32 v132, v132
    v_mfma_f32_16x16x32_bf16 a[60:63], a[148:151], v[88:91], a[60:63]
    v_fma_f32 v134, v134, s58, -v12
    v_exp_f32 v133, v133
    v_cvt_pk_bf16_f32 v129, v130, v131
    v_fma_f32 v135, v135, s58, -v12
    v_mfma_f32_16x16x32_bf16 a[64:67], a[148:151], v[96:99], a[64:67]
    v_exp_f32 v134, v134
    v_exp_f32 v135, v135
    v_cvt_pk_bf16_f32 v130, v132, v133
    v_cvt_pk_bf16_f32 v131, v134, v135
    v_mfma_f32_16x16x32_bf16 a[68:71], a[148:151], v[104:107], a[68:71]
    v_fma_f32 v136, v136, s58, -v10
    v_fma_f32 v137, v137, s58, -v10
    v_exp_f32 v136, v136
    v_fma_f32 v138, v138, s58, -v10
    v_exp_f32 v137, v137
    v_mfma_f32_16x16x32_bf16 a[72:75], a[152:155], v[88:91], a[72:75]
    v_fma_f32 v139, v139, s58, -v10
    v_exp_f32 v138, v138
    v_fma_f32 v140, v140, s58, -v10
    v_exp_f32 v139, v139
    v_cvt_pk_bf16_f32 v136, v136, v137
    v_mfma_f32_16x16x32_bf16 a[76:79], a[152:155], v[96:99], a[76:79]
    s_waitcnt vmcnt(10)
    ds_read_b64_tr_b16 a[208:209], v162 offset:28672
    ds_read_b64_tr_b16 a[210:211], v162 offset:32768
    v_fma_f32 v141, v141, s58, -v10
    v_exp_f32 v140, v140
    v_fma_f32 v142, v142, s58, -v10
    v_exp_f32 v141, v141
    v_mfma_f32_16x16x32_bf16 a[80:83], a[152:155], v[104:107], a[80:83]
    ds_read_b64_tr_b16 a[212:213], v163 offset:28672
    ds_read_b64_tr_b16 a[214:215], v163 offset:32768
    v_cvt_pk_bf16_f32 v137, v138, v139
    v_fma_f32 v143, v143, s58, -v10
    v_exp_f32 v142, v142
    v_exp_f32 v143, v143
    v_cvt_pk_bf16_f32 v138, v140, v141
    v_mfma_f32_16x16x32_bf16 a[84:87], a[156:159], v[88:91], a[84:87]
    ds_read_b64_tr_b16 a[216:217], v164 offset:28672
    ds_read_b64_tr_b16 a[218:219], v164 offset:32768
    v_cvt_pk_bf16_f32 v139, v142, v143
    v_fma_f32 v144, v144, s58, -v11
    v_fma_f32 v145, v145, s58, -v11
    v_exp_f32 v144, v144
    v_fma_f32 v146, v146, s58, -v11
    v_mfma_f32_16x16x32_bf16 a[88:91], a[156:159], v[96:99], a[88:91]
    s_add_u32 m0, s43, 24576
    s_bfe_u32 s57, s56, 0x40008
    s_lshl_b32 s57, s57, 18
    buffer_load_dwordx4 v168, s[60:63], s57 offen offset:0 lds
    ds_read_b64_tr_b16 a[220:221], v165 offset:28672
    ds_read_b64_tr_b16 a[222:223], v165 offset:32768
    v_exp_f32 v145, v145
    v_fma_f32 v147, v147, s58, -v11
    v_exp_f32 v146, v146
    v_fma_f32 v148, v148, s58, -v11
    v_mfma_f32_16x16x32_bf16 a[92:95], a[156:159], v[104:107], a[92:95]
    v_exp_f32 v147, v147
    v_cvt_pk_bf16_f32 v144, v144, v145
    v_fma_f32 v149, v149, s58, -v11
    v_exp_f32 v148, v148
    v_fma_f32 v150, v150, s58, -v11
    v_mfma_f32_16x16x32_bf16 a[96:99], a[160:163], v[88:91], a[96:99]
    buffer_load_dwordx4 v169, s[60:63], s57 offen offset:1024 lds
    ds_read_b64_tr_b16 a[224:225], v166 offset:28672
    ds_read_b64_tr_b16 a[226:227], v166 offset:32768
    v_exp_f32 v149, v149
    v_cvt_pk_bf16_f32 v145, v146, v147
    v_fma_f32 v151, v151, s58, -v11
    v_exp_f32 v150, v150
    v_mfma_f32_16x16x32_bf16 a[100:103], a[160:163], v[96:99], a[100:103]
    ds_read_b64_tr_b16 a[228:229], v167 offset:28672
    ds_read_b64_tr_b16 a[230:231], v167 offset:32768
    v_exp_f32 v151, v151
    v_cvt_pk_bf16_f32 v146, v148, v149
    v_cvt_pk_bf16_f32 v147, v150, v151
    v_fma_f32 v152, v152, s58, -v12
    v_fma_f32 v153, v153, s58, -v12
    v_mfma_f32_16x16x32_bf16 a[104:107], a[160:163], v[104:107], a[104:107]
    buffer_load_dwordx4 v170, s[60:63], s57 offen offset:2048 lds
    ds_read_b64_tr_b16 a[200:201], v160 offset:28672
    ds_read_b64_tr_b16 a[202:203], v160 offset:32768
    v_exp_f32 v152, v152
    v_fma_f32 v154, v154, s58, -v12
    v_exp_f32 v153, v153
    v_fma_f32 v155, v155, s58, -v12
    v_exp_f32 v154, v154
    v_mfma_f32_16x16x32_bf16 a[108:111], a[164:167], v[88:91], a[108:111]
    ds_read_b64_tr_b16 a[204:205], v161 offset:28672
    ds_read_b64_tr_b16 a[206:207], v161 offset:32768
    v_fma_f32 v156, v156, s58, -v12
    v_exp_f32 v155, v155
    v_cvt_pk_bf16_f32 v152, v152, v153
    v_fma_f32 v157, v157, s58, -v12
    v_mfma_f32_16x16x32_bf16 a[112:115], a[164:167], v[96:99], a[112:115]
    buffer_load_dwordx4 v171, s[60:63], s57 offen offset:3072 lds
    v_exp_f32 v156, v156
    v_fma_f32 v158, v158, s58, -v12
    v_exp_f32 v157, v157
    v_cvt_pk_bf16_f32 v153, v154, v155
    v_fma_f32 v159, v159, s58, -v12
    v_mfma_f32_16x16x32_bf16 a[116:119], a[164:167], v[104:107], a[116:119]
    v_exp_f32 v158, v158
    v_exp_f32 v159, v159
    v_cvt_pk_bf16_f32 v154, v156, v157
    v_cvt_pk_bf16_f32 v155, v158, v159
    v_mfma_f32_16x16x32_bf16 v[180:183], a[132:135], v[112:115], v[180:183]
    v_mfma_f32_16x16x32_bf16 v[180:183], a[132:135], v[136:139], v[180:183]
    v_mfma_f32_16x16x32_bf16 v[184:187], a[132:135], v[120:123], v[184:187]
    v_mfma_f32_16x16x32_bf16 v[184:187], a[132:135], v[144:147], v[184:187]
    v_mfma_f32_16x16x32_bf16 v[188:191], a[132:135], v[128:131], v[188:191]
    v_mfma_f32_16x16x32_bf16 v[188:191], a[132:135], v[152:155], v[188:191]
    s_waitcnt lgkmcnt(0)
    v_mfma_f32_16x16x32_bf16 a[48:51], a[176:179], v[112:115], a[48:51]
    s_add_u32 m0, s43, 0
    s_bfe_u32 s57, s56, 0x4000c
    s_lshl_b32 s57, s57, 18
    buffer_load_dwordx4 v168, s[60:63], s57 offen offset:0 lds
    s_waitcnt vmcnt(9)
    v_cmp_ne_u32 vcc, s11, v249
    v_mfma_f32_16x16x32_bf16 a[48:51], a[208:211], v[136:139], a[48:51]
    v_mfma_f32_16x16x32_bf16 a[60:63], a[180:183], v[112:115], a[60:63]
    v_mfma_f32_16x16x32_bf16 a[60:63], a[212:215], v[136:139], a[60:63]
    s_cmp_eq_u64 vcc, 0
    s_cselect_b32 s10, 1, 0
    v_mfma_f32_16x16x32_bf16 a[72:75], a[184:187], v[112:115], a[72:75]
    v_mfma_f32_16x16x32_bf16 a[72:75], a[216:219], v[136:139], a[72:75]
    v_mov_b32 v181, v184
    v_mov_b32 v182, v188
    ds_write_b96 v172, v[180:182] offset:36864
    buffer_load_dwordx4 v169, s[60:63], s57 offen offset:1024 lds
    v_mfma_f32_16x16x32_bf16 a[84:87], a[188:191], v[112:115], a[84:87]
    v_mfma_f32_16x16x32_bf16 a[84:87], a[220:223], v[136:139], a[84:87]
    ds_write_b128 v172, a[48:51] offset:4096
    v_mfma_f32_16x16x32_bf16 a[96:99], a[192:195], v[112:115], a[96:99]
    v_mfma_f32_16x16x32_bf16 a[96:99], a[224:227], v[136:139], a[96:99]
    ds_write_b128 v172, a[60:63] offset:5120
    v_mfma_f32_16x16x32_bf16 a[108:111], a[196:199], v[112:115], a[108:111]
    v_mfma_f32_16x16x32_bf16 a[108:111], a[228:231], v[136:139], a[108:111]
    ds_write_b128 v172, a[72:75] offset:6144
    buffer_load_dwordx4 v170, s[60:63], s57 offen offset:2048 lds
    v_mfma_f32_16x16x32_bf16 a[52:55], a[176:179], v[120:123], a[52:55]
    v_mfma_f32_16x16x32_bf16 a[52:55], a[208:211], v[144:147], a[52:55]
    ds_write_b128 v172, a[84:87] offset:7168
    v_mfma_f32_16x16x32_bf16 a[64:67], a[180:183], v[120:123], a[64:67]
    v_mfma_f32_16x16x32_bf16 a[64:67], a[212:215], v[144:147], a[64:67]
    v_mfma_f32_16x16x32_bf16 a[76:79], a[184:187], v[120:123], a[76:79]
    ds_write_b128 v172, a[96:99] offset:16384
    buffer_load_dwordx4 v171, s[60:63], s57 offen offset:3072 lds
    v_mfma_f32_16x16x32_bf16 a[76:79], a[216:219], v[144:147], a[76:79]
    v_mfma_f32_16x16x32_bf16 v[40:43], a[168:171], v[112:115], v[40:43]
    ds_write_b128 v172, a[108:111] offset:17408
    v_mfma_f32_16x16x32_bf16 v[40:43], a[200:203], v[136:139], v[40:43]
    v_mfma_f32_16x16x32_bf16 v[52:55], a[172:175], v[112:115], v[52:55]
    ds_write_b128 v172, a[52:55] offset:18432
    v_mfma_f32_16x16x32_bf16 v[52:55], a[204:207], v[136:139], v[52:55]
    s_waitcnt lgkmcnt(1)
    s_barrier
    ds_read_b96 v[200:202], v173 offset:36864
    ds_read_b96 v[216:218], v174 offset:36864
    ds_read_b96 v[208:210], v175 offset:36864
    v_mfma_f32_16x16x32_bf16 a[88:91], a[188:191], v[120:123], a[88:91]
    ds_read_b128 v[64:67], v173 offset:4096
    ds_read_b128 v[68:71], v173 offset:5120
    v_mfma_f32_16x16x32_bf16 a[88:91], a[220:223], v[144:147], a[88:91]
    ds_read_b128 v[72:75], v174 offset:6144
    ds_read_b128 v[76:79], v174 offset:7168
    ds_write_b128 v172, a[64:67] offset:19456
    v_mfma_f32_16x16x32_bf16 a[100:103], a[192:195], v[120:123], a[100:103]
    ds_read_b128 v[80:83], v175 offset:16384
    ds_read_b128 v[84:87], v175 offset:17408
    v_mfma_f32_16x16x32_bf16 a[100:103], a[224:227], v[144:147], a[100:103]
    ds_write_b128 v172, a[76:79] offset:20480
    s_add_u32 m0, s43, 28672
    s_bfe_u32 s57, s56, 0x40010
    s_lshl_b32 s57, s57, 18
    buffer_load_dwordx4 v168, s[60:63], s57 offen offset:0 lds
    s_waitcnt lgkmcnt(7)
    v_add_f32 v180, v180, v216
    v_add_f32 v181, v181, v217
    v_add_f32 v182, v182, v218
    v_add_f32 v208, v208, v200
    v_add_f32 v209, v209, v201
    v_add_f32 v210, v210, v202
    v_mfma_f32_16x16x32_bf16 a[112:115], a[196:199], v[120:123], a[112:115]
    v_add_f32 v180, v180, v208
    v_add_f32 v181, v181, v209
    v_add_f32 v182, v182, v210
    v_add_f32 v5, v180, v181
    v_rcp_f32 v214, v180
    v_mfma_f32_16x16x32_bf16 a[112:115], a[228:231], v[144:147], a[112:115]
    v_rcp_f32 v216, v181
    v_rcp_f32 v218, v182
    v_add_f32 v5, v5, v182
    v_cmp_ngt_f32 vcc, s52, v5
    s_cbranch_vccnz L_chk
L_chk_ok:
    v_add_f32 v40, v40, v64
    v_mfma_f32_16x16x32_bf16 a[56:59], a[176:179], v[128:131], a[56:59]
    ds_write_b128 v172, a[88:91] offset:21504
    buffer_load_dwordx4 v169, s[60:63], s57 offen offset:1024 lds
    v_add_f32 v41, v41, v65
    v_add_f32 v42, v42, v66
    v_add_f32 v43, v43, v67
    s_waitcnt lgkmcnt(1)
    v_add_f32 v52, v52, v68
    v_add_f32 v53, v53, v69
    v_mfma_f32_16x16x32_bf16 a[56:59], a[208:211], v[152:155], a[56:59]
    v_add_f32 v54, v54, v70
    v_add_f32 v55, v55, v71
    v_add_f32 v40, v40, v72
    v_add_f32 v41, v41, v73
    v_add_f32 v42, v42, v74
    v_mfma_f32_16x16x32_bf16 a[68:71], a[180:183], v[128:131], a[68:71]
    ds_write_b128 v172, a[100:103] offset:22528
    v_add_f32 v43, v43, v75
    v_add_f32 v52, v52, v76
    v_add_f32 v53, v53, v77
    v_add_f32 v54, v54, v78
    v_add_f32 v55, v55, v79
    v_add_f32 v40, v40, v80
    v_mfma_f32_16x16x32_bf16 a[68:71], a[212:215], v[152:155], a[68:71]
    buffer_load_dwordx4 v170, s[60:63], s57 offen offset:2048 lds
    v_add_f32 v41, v41, v81
    v_add_f32 v42, v42, v82
    v_add_f32 v43, v43, v83
    v_add_f32 v52, v52, v84
    v_add_f32 v53, v53, v85
    v_mfma_f32_16x16x32_bf16 a[80:83], a[184:187], v[128:131], a[80:83]
    ds_write_b128 v172, a[112:115] offset:23552
    v_add_f32 v54, v54, v86
    v_add_f32 v55, v55, v87
    v_mul_f32 v40, v214, v40
    v_mul_f32 v41, v214, v41
    v_mul_f32 v42, v214, v42
    v_mfma_f32_16x16x32_bf16 a[80:83], a[216:219], v[152:155], a[80:83]
    v_mul_f32 v43, v214, v43
    v_mul_f32 v52, v214, v52
    v_mul_f32 v53, v214, v53
    v_mul_f32 v54, v214, v54
    v_mul_f32 v55, v214, v55
    v_mfma_f32_16x16x32_bf16 v[44:47], a[168:171], v[120:123], v[44:47]
    v_cvt_pk_bf16_f32 v232, v40, v41
    v_cvt_pk_bf16_f32 v233, v42, v43
    v_cvt_pk_bf16_f32 v234, v52, v53
    v_cvt_pk_bf16_f32 v235, v54, v55
    s_add_u32 s45, s40, 0
    buffer_store_dwordx4 v[232:235], v36, s[36:39], s45 offen sc1
    s_waitcnt lgkmcnt(0)
    s_barrier
    ds_read_b128 v[88:91], v173 offset:18432
    ds_read_b128 v[92:95], v173 offset:19456
    v_mfma_f32_16x16x32_bf16 v[44:47], a[200:203], v[144:147], v[44:47]
    ds_read_b128 v[96:99], v174 offset:20480
    ds_read_b128 v[100:103], v174 offset:21504
    ds_write_b128 v172, a[56:59] offset:4096
    v_mfma_f32_16x16x32_bf16 v[56:59], a[172:175], v[120:123], v[56:59]
    ds_read_b128 v[104:107], v175 offset:22528
    ds_read_b128 v[108:111], v175 offset:23552
    v_mfma_f32_16x16x32_bf16 v[56:59], a[204:207], v[144:147], v[56:59]
    ds_write_b128 v172, a[68:71] offset:5120
    buffer_load_dwordx4 v171, s[60:63], s57 offen offset:3072 lds
    v_mfma_f32_16x16x32_bf16 a[92:95], a[188:191], v[128:131], a[92:95]
    v_mfma_f32_16x16x32_bf16 a[92:95], a[220:223], v[152:155], a[92:95]
    ds_write_b128 v172, a[80:83] offset:6144
    v_mfma_f32_16x16x32_bf16 a[104:107], a[192:195], v[128:131], a[104:107]
    s_add_u32 m0, s43, 32768
    s_bfe_u32 s57, s56, 0x40014
    s_lshl_b32 s57, s57, 18
    buffer_load_dwordx4 v168, s[60:63], s57 offen offset:0 lds
    v_mfma_f32_16x16x32_bf16 a[104:107], a[224:227], v[152:155], a[104:107]
    s_waitcnt lgkmcnt(4)
    v_add_f32 v44, v44, v88
    v_add_f32 v45, v45, v89
    v_mfma_f32_16x16x32_bf16 a[116:119], a[196:199], v[128:131], a[116:119]
    v_add_f32 v46, v46, v90
    v_add_f32 v47, v47, v91
    v_mfma_f32_16x16x32_bf16 a[116:119], a[228:231], v[152:155], a[116:119]
    v_add_f32 v56, v56, v92
    v_add_f32 v57, v57, v93
    v_mfma_f32_16x16x32_bf16 v[48:51], a[168:171], v[128:131], v[48:51]
    ds_write_b128 v172, a[92:95] offset:7168
    buffer_load_dwordx4 v169, s[60:63], s57 offen offset:1024 lds
    v_add_f32 v58, v58, v94
    v_mfma_f32_16x16x32_bf16 v[48:51], a[200:203], v[152:155], v[48:51]
    v_add_f32 v59, v59, v95
    v_add_f32 v44, v44, v96
    v_mfma_f32_16x16x32_bf16 v[60:63], a[172:175], v[128:131], v[60:63]
    ds_write_b128 v172, a[104:107] offset:16384
    v_add_f32 v45, v45, v97
    v_add_f32 v46, v46, v98
    v_mfma_f32_16x16x32_bf16 v[60:63], a[204:207], v[152:155], v[60:63]
    v_add_f32 v47, v47, v99
    ds_write_b128 v172, a[116:119] offset:17408
    v_pk_add_f32 v[56:57], v[56:57], v[100:101]
    v_pk_add_f32 v[58:59], v[58:59], v[102:103]
    s_waitcnt lgkmcnt(2)
    v_pk_add_f32 v[44:45], v[44:45], v[104:105]
    v_pk_add_f32 v[46:47], v[46:47], v[106:107]
    v_pk_add_f32 v[56:57], v[56:57], v[108:109]
    v_pk_add_f32 v[58:59], v[58:59], v[110:111]
    v_pk_mul_f32 v[44:45], v[44:45], v[216:217] op_sel_hi:[1,0]
    v_pk_mul_f32 v[46:47], v[46:47], v[216:217] op_sel_hi:[1,0]
    v_pk_mul_f32 v[56:57], v[56:57], v[216:217] op_sel_hi:[1,0]
    v_pk_mul_f32 v[58:59], v[58:59], v[216:217] op_sel_hi:[1,0]
    v_cvt_pk_bf16_f32 v236, v44, v45
    v_cvt_pk_bf16_f32 v237, v46, v47
    v_cvt_pk_bf16_f32 v238, v56, v57
    v_cvt_pk_bf16_f32 v239, v58, v59
    s_add_u32 s45, s40, 32768
    buffer_store_dwordx4 v[236:239], v36, s[36:39], s45 offen sc1
    s_waitcnt vmcnt(12)
    s_waitcnt lgkmcnt(0)
    s_barrier
    ds_read_b128 v[64:67], v173 offset:4096
    ds_read_b128 v[68:71], v173 offset:5120
    ds_read_b128 v[72:75], v174 offset:6144
    ds_read_b128 v[76:79], v174 offset:7168
    ds_read_b128 v[80:83], v175 offset:16384
    ds_read_b128 v[84:87], v175 offset:17408
    s_waitcnt lgkmcnt(5)
    v_pk_add_f32 v[48:49], v[48:49], v[64:65]
    ds_read_b64_tr_b16 a[0:1], v224 offset:12288
    ds_read_b64_tr_b16 a[2:3], v224 offset:14336
    v_pk_add_f32 v[50:51], v[50:51], v[66:67]
    s_waitcnt lgkmcnt(6)
    v_pk_add_f32 v[60:61], v[60:61], v[68:69]
    v_pk_add_f32 v[62:63], v[62:63], v[70:71]
    s_waitcnt lgkmcnt(5)
    v_pk_add_f32 v[48:49], v[48:49], v[72:73]
    v_pk_add_f32 v[50:51], v[50:51], v[74:75]
    ds_read_b64_tr_b16 a[4:5], v225 offset:12288
    ds_read_b64_tr_b16 a[6:7], v225 offset:14336
    s_waitcnt lgkmcnt(5)
    v_pk_add_f32 v[60:61], v[60:61], v[76:77]
    v_pk_add_f32 v[62:63], v[62:63], v[78:79]
    v_pk_add_f32 v[48:49], v[48:49], v[80:81]
    v_pk_add_f32 v[50:51], v[50:51], v[82:83]
    s_waitcnt lgkmcnt(2)
    v_pk_add_f32 v[60:61], v[60:61], v[84:85]
    ds_read_b64_tr_b16 a[8:9], v226 offset:12288
    ds_read_b64_tr_b16 a[10:11], v226 offset:14336
    v_pk_add_f32 v[62:63], v[62:63], v[86:87]
    v_pk_mul_f32 v[48:49], v[48:49], v[218:219] op_sel_hi:[1,0]
    v_pk_mul_f32 v[50:51], v[50:51], v[218:219] op_sel_hi:[1,0]
    v_pk_mul_f32 v[60:61], v[60:61], v[218:219] op_sel_hi:[1,0]
    v_pk_mul_f32 v[62:63], v[62:63], v[218:219] op_sel_hi:[1,0]
    ds_read_b64_tr_b16 a[12:13], v227 offset:12288
    ds_read_b64_tr_b16 a[14:15], v227 offset:14336
    v_cvt_pk_bf16_f32 v240, v48, v49
    v_cvt_pk_bf16_f32 v241, v50, v51
    v_cvt_pk_bf16_f32 v242, v60, v61
    v_cvt_pk_bf16_f32 v243, v62, v63
    s_add_u32 s45, s40, 65536
    buffer_store_dwordx4 v[240:243], v36, s[36:39], s45 offen sc1
    s_waitcnt vmcnt(5)
    v_mov_b32 v6, 1
    s_cmp_eq_u32 s10, 0
    s_cbranch_scc1 L_fl0_far
    buffer_store_dword v6, v8, s[64:67], s6 offen
L_fl0_done:
    ds_read_b64_tr_b16 a[16:17], v228 offset:12288
    ds_read_b64_tr_b16 a[18:19], v228 offset:14336
    buffer_load_dwordx4 v170, s[60:63], s57 offen offset:2048 lds
    ds_read_b64_tr_b16 a[20:21], v229 offset:12288
    ds_read_b64_tr_b16 a[22:23], v229 offset:14336
    ds_read_b64_tr_b16 a[24:25], v230 offset:12288
    ds_read_b64_tr_b16 a[26:27], v230 offset:14336
    ds_read_b64_tr_b16 a[28:29], v231 offset:12288
    ds_read_b64_tr_b16 a[30:31], v231 offset:14336
    buffer_load_dwordx4 v171, s[60:63], s57 offen offset:3072 lds
    ds_read_b64_tr_b16 a[32:33], v224 offset:8192
    ds_read_b64_tr_b16 a[34:35], v224 offset:10240
    ds_read_b64_tr_b16 a[36:37], v225 offset:8192
    ds_read_b64_tr_b16 a[38:39], v225 offset:10240
    s_waitcnt vmcnt(4)
    v_mov_b32 v6, 2
    s_cmp_eq_u32 s10, 0
    s_cbranch_scc1 L_fl1_far
    buffer_store_dword v6, v8, s[64:67], s6 offen
L_fl1_done:
    ds_read_b64_tr_b16 a[40:41], v226 offset:8192
    ds_read_b64_tr_b16 a[42:43], v226 offset:10240
    s_add_u32 m0, s43, 36864
    s_bfe_u32 s57, s56, 0x40018
    s_lshl_b32 s57, s57, 18
    buffer_load_dwordx4 v168, s[60:63], s57 offen offset:0 lds
    ds_read_b64_tr_b16 a[44:45], v227 offset:8192
    ds_read_b64_tr_b16 a[46:47], v227 offset:10240
    ds_read_b64_tr_b16 a[48:49], v228 offset:8192
    ds_read_b64_tr_b16 a[50:51], v228 offset:10240
    ds_read_b64_tr_b16 a[52:53], v229 offset:8192
    ds_read_b64_tr_b16 a[54:55], v229 offset:10240
    buffer_load_dwordx4 v169, s[60:63], s57 offen offset:1024 lds
    ds_read_b64_tr_b16 a[56:57], v230 offset:8192
    ds_read_b64_tr_b16 a[58:59], v230 offset:10240
    ds_read_b64_tr_b16 a[60:61], v231 offset:8192
    ds_read_b64_tr_b16 a[62:63], v231 offset:10240
    s_waitcnt vmcnt(6)
    v_mov_b32 v6, 3
    s_cmp_eq_u32 s10, 0
    s_cbranch_scc1 L_fl2_far
    buffer_store_dword v6, v8, s[64:67], s6 offen
L_fl2_done:
    ds_read_b64_tr_b16 a[64:65], v224 offset:24576
    ds_read_b64_tr_b16 a[66:67], v224 offset:26624
    buffer_load_dwordx4 v170, s[60:63], s57 offen offset:2048 lds
    ds_read_b64_tr_b16 a[68:69], v225 offset:24576
    ds_read_b64_tr_b16 a[70:71], v225 offset:26624
    ds_read_b64_tr_b16 a[72:73], v226 offset:24576
    ds_read_b64_tr_b16 a[74:75], v226 offset:26624
    buffer_load_dwordx4 v171, s[60:63], s57 offen offset:3072 lds
    ds_read_b64_tr_b16 a[76:77], v227 offset:24576
    ds_read_b64_tr_b16 a[78:79], v227 offset:26624
    ds_read_b64_tr_b16 a[80:81], v228 offset:24576
    ds_read_b64_tr_b16 a[82:83], v228 offset:26624
    s_add_u32 m0, s43, 20480
    s_bfe_u32 s57, s56, 0x4001c
    s_lshl_b32 s57, s57, 18
    buffer_load_dwordx4 v168, s[60:63], s57 offen offset:0 lds
    ds_read_b64_tr_b16 a[84:85], v229 offset:24576
    ds_read_b64_tr_b16 a[86:87], v229 offset:26624
    ds_read_b64_tr_b16 a[88:89], v230 offset:24576
    ds_read_b64_tr_b16 a[90:91], v230 offset:26624
    buffer_load_dwordx4 v169, s[60:63], s57 offen offset:1024 lds
    ds_read_b64_tr_b16 a[92:93], v231 offset:24576
    ds_read_b64_tr_b16 a[94:95], v231 offset:26624
    buffer_load_dword v251, v13, s[64:67], s5 offen sc1
    s_waitcnt lgkmcnt(0)
    s_barrier
    buffer_load_dwordx4 v170, s[60:63], s57 offen offset:2048 lds
    ds_read_b64_tr_b16 a[96:97], v224 offset:0
    ds_read_b64_tr_b16 a[98:99], v224 offset:2048
    ds_read_b64_tr_b16 a[100:101], v225 offset:0
    ds_read_b64_tr_b16 a[102:103], v225 offset:2048
    ds_read_b64_tr_b16 a[104:105], v226 offset:0
    ds_read_b64_tr_b16 a[106:107], v226 offset:2048
    ds_read_b64_tr_b16 a[108:109], v227 offset:0
    ds_read_b64_tr_b16 a[110:111], v227 offset:2048
    ds_read_b64_tr_b16 a[112:113], v228 offset:0
    ds_read_b64_tr_b16 a[114:115], v228 offset:2048
    ds_read_b64_tr_b16 a[116:117], v229 offset:0
    ds_read_b64_tr_b16 a[118:119], v229 offset:2048
    ds_read_b64_tr_b16 a[120:121], v230 offset:0
    ds_read_b64_tr_b16 a[122:123], v230 offset:2048
    ds_read_b64_tr_b16 a[124:125], v231 offset:0
    ds_read_b64_tr_b16 a[126:127], v231 offset:2048
    buffer_load_dwordx4 v171, s[60:63], s57 offen offset:3072 lds
    ds_read_b64_tr_b16 a[128:129], v224 offset:28672
    ds_read_b64_tr_b16 a[130:131], v224 offset:30720
    ds_read_b64_tr_b16 a[132:133], v225 offset:28672
    ds_read_b64_tr_b16 a[134:135], v225 offset:30720
    ds_read_b64_tr_b16 a[136:137], v226 offset:28672
    ds_read_b64_tr_b16 a[138:139], v226 offset:30720
    ds_read_b64_tr_b16 a[140:141], v227 offset:28672
    ds_read_b64_tr_b16 a[142:143], v227 offset:30720
    ds_read_b64_tr_b16 a[144:145], v228 offset:28672
    ds_read_b64_tr_b16 a[146:147], v228 offset:30720
    ds_read_b64_tr_b16 a[148:149], v229 offset:28672
    ds_read_b64_tr_b16 a[150:151], v229 offset:30720
    ds_read_b64_tr_b16 a[152:153], v230 offset:28672
    ds_read_b64_tr_b16 a[154:155], v230 offset:30720
    ds_read_b64_tr_b16 a[156:157], v231 offset:28672
    ds_read_b64_tr_b16 a[158:159], v231 offset:30720
    v_and_b32 v5, 1, v3
    v_lshlrev_b32 v5, 5, v5
    v_lshrrev_b32 v7, 1, v3
    v_lshl_add_u32 v5, v7, 4, v5
    v_lshl_add_u32 v11, v4, 11, v5
    s_lshr_b32 s45, s48, 1
    s_add_u32 s12, s16, s45
    s_mul_i32 s12, s12, 98304
    s_add_u32 s12, s12, s17
    s_and_b32 s45, s48, 1
    s_lshl_b32 s45, s45, 6
    s_add_u32 s12, s12, s45
    s_add_u32 s13, s12, 32768
    s_add_u32 s14, s12, 65536
    s_add_u32 s45, s48, 1
    s_and_b32 s45, s45, 3
    s_mul_i32 s45, s45, 6144
    s_add_u32 s76, s45, s9
    s_add_u32 s77, s76, 4096
    s_add_u32 s45, s48, 2
    s_and_b32 s45, s45, 3
    s_mul_i32 s45, s45, 6144
    s_add_u32 s78, s45, s9
    s_add_u32 s79, s78, 4096
    s_add_u32 s45, s48, 3
    s_and_b32 s45, s45, 3
    s_mul_i32 s45, s45, 6144
    s_add_u32 s80, s45, s9
    s_add_u32 s81, s80, 4096
    v_sub_u32 v15, v199, v36
    v_add_u32 v15, v15, v8
    v_min_u32 v5, 2, v2
    s_add_u32 s45, s48, 1
    v_add_u32 v5, s45, v5
    v_and_b32 v5, 3, v5
    v_lshlrev_b32 v5, 2, v5
    s_lshl_b32 s15, s41, 7
    s_add_u32 s15, s15, s4
    s_add_u32 s15, s15, 2048
    v_add_u32 v10, 8192, v9
    s_bfe_u32 s82, s56, 0x40000
    s_lshl_b32 s82, s82, 10
    s_add_u32 s86, s82, 32768
    s_add_u32 s90, s82, 65536
    s_bfe_u32 s83, s56, 0x40008
    s_lshl_b32 s83, s83, 10
    s_add_u32 s87, s83, 32768
    s_add_u32 s91, s83, 65536
    s_bfe_u32 s84, s56, 0x40010
    s_lshl_b32 s84, s84, 10
    s_add_u32 s88, s84, 32768
    s_add_u32 s92, s84, 65536
    s_bfe_u32 s85, s56, 0x40018
    s_lshl_b32 s85, s85, 10
    s_add_u32 s89, s85, 32768
    s_add_u32 s93, s85, 65536
    s_waitcnt vmcnt(2)
    v_cmp_gt_u32 vcc, 1, v251
    s_cbranch_vccnz L_p0_slow
L_p0_ok:
    buffer_load_dwordx4 v[64:67], v9, s[36:39], s82 offen offset:0 sc1
    buffer_load_dwordx4 v[68:71], v10, s[36:39], s82 offen offset:0 sc1
    buffer_load_dwordx4 v[72:75], v9, s[36:39], s82 offen offset:1024 sc1
    buffer_load_dwordx4 v[76:79], v10, s[36:39], s82 offen offset:1024 sc1
    buffer_load_dword v252, v13, s[64:67], s5 offen sc1
    buffer_load_dwordx4 v[80:83], v9, s[36:39], s83 offen offset:0 sc1
    s_waitcnt vmcnt(6)
    s_waitcnt lgkmcnt(0)
    s_barrier
    ds_read_b64_tr_b16 a[160:161], v224 offset:32768
    ds_read_b64_tr_b16 a[162:163], v224 offset:34816
    buffer_load_dwordx4 v[84:87], v10, s[36:39], s83 offen offset:0 sc1
    ds_read_b64_tr_b16 a[164:165], v225 offset:32768
    ds_read_b64_tr_b16 a[166:167], v225 offset:34816
    ds_read_b64_tr_b16 a[168:169], v226 offset:32768
    ds_read_b64_tr_b16 a[170:171], v226 offset:34816
    ds_read_b64_tr_b16 a[172:173], v227 offset:32768
    ds_read_b64_tr_b16 a[174:175], v227 offset:34816
    ds_read_b64_tr_b16 a[176:177], v228 offset:32768
    ds_read_b64_tr_b16 a[178:179], v228 offset:34816
    buffer_load_dwordx4 v[88:91], v9, s[36:39], s83 offen offset:1024 sc1
    ds_read_b64_tr_b16 a[180:181], v229 offset:32768
    ds_read_b64_tr_b16 a[182:183], v229 offset:34816
    ds_read_b64_tr_b16 a[184:185], v230 offset:32768
    ds_read_b64_tr_b16 a[186:187], v230 offset:34816
    ds_read_b64_tr_b16 a[188:189], v231 offset:32768
    ds_read_b64_tr_b16 a[190:191], v231 offset:34816
    ds_read_b64_tr_b16 a[192:193], v224 offset:36864
    ds_read_b64_tr_b16 a[194:195], v224 offset:38912
L_pad4:
    s_cbranch_execz L_warm_ret
    s_nop 0
    buffer_load_dwordx4 v[92:95], v10, s[36:39], s83 offen offset:1024 sc1
    ds_read_b64_tr_b16 a[196:197], v225 offset:36864
    ds_read_b64_tr_b16 a[198:199], v225 offset:38912
    ds_read_b64_tr_b16 a[200:201], v226 offset:36864
    ds_read_b64_tr_b16 a[202:203], v226 offset:38912
    ds_read_b64_tr_b16 a[204:205], v227 offset:36864
    ds_read_b64_tr_b16 a[206:207], v227 offset:38912
    ds_read_b64_tr_b16 a[208:209], v228 offset:36864
    ds_read_b64_tr_b16 a[210:211], v228 offset:38912
    buffer_load_dwordx4 v[96:99], v9, s[36:39], s84 offen offset:0 sc1
    ds_read_b64_tr_b16 a[212:213], v229 offset:36864
    ds_read_b64_tr_b16 a[214:215], v229 offset:38912
    ds_read_b64_tr_b16 a[216:217], v230 offset:36864
    ds_read_b64_tr_b16 a[218:219], v230 offset:38912
    ds_read_b64_tr_b16 a[220:221], v231 offset:36864
    ds_read_b64_tr_b16 a[222:223], v231 offset:38912
    ds_read_b64_tr_b16 a[224:225], v224 offset:20480
    ds_read_b64_tr_b16 a[226:227], v224 offset:22528
    buffer_load_dwordx4 v[100:103], v10, s[36:39], s84 offen offset:0 sc1
    ds_read_b64_tr_b16 a[228:229], v225 offset:20480
    ds_read_b64_tr_b16 a[230:231], v225 offset:22528
    ds_read_b64_tr_b16 a[232:233], v226 offset:20480
    ds_read_b64_tr_b16 a[234:235], v226 offset:22528
    ds_read_b64_tr_b16 a[236:237], v227 offset:20480
    ds_read_b64_tr_b16 a[238:239], v227 offset:22528
    ds_read_b64_tr_b16 a[240:241], v228 offset:20480
    ds_read_b64_tr_b16 a[242:243], v228 offset:22528
    buffer_load_dwordx4 v[104:107], v9, s[36:39], s84 offen offset:1024 sc1
    ds_read_b64_tr_b16 a[244:245], v229 offset:20480
    ds_read_b64_tr_b16 a[246:247], v229 offset:22528
    ds_read_b64_tr_b16 a[248:249], v230 offset:20480
    ds_read_b64_tr_b16 a[250:251], v230 offset:22528
    ds_read_b64_tr_b16 a[252:253], v231 offset:20480
    ds_read_b64_tr_b16 a[254:255], v231 offset:22528
    s_waitcnt vmcnt(8)
    v_mfma_f32_16x16x32_bf16 v[180:183], a[8:11], v[64:67], 0
    buffer_load_dwordx4 v[108:111], v10, s[36:39], s84 offen offset:1024 sc1
    v_mfma_f32_16x16x32_bf16 v[180:183], a[24:27], v[68:71], v[180:183]
    v_mfma_f32_16x16x32_bf16 v[180:183], a[40:43], v[72:75], v[180:183]
    v_mfma_f32_16x16x32_bf16 v[180:183], a[56:59], v[76:79], v[180:183]
    buffer_load_dwordx4 v[112:115], v9, s[36:39], s85 offen offset:0 sc1
    v_mfma_f32_16x16x32_bf16 v[184:187], a[12:15], v[64:67], 0
    v_mfma_f32_16x16x32_bf16 v[184:187], a[28:31], v[68:71], v[184:187]
    v_mfma_f32_16x16x32_bf16 v[184:187], a[44:47], v[72:75], v[184:187]
    buffer_load_dwordx4 v[116:119], v10, s[36:39], s85 offen offset:0 sc1
    v_mfma_f32_16x16x32_bf16 v[184:187], a[60:63], v[76:79], v[184:187]
    v_mfma_f32_16x16x32_bf16 v[40:43], a[0:3], v[64:67], 0
    v_mfma_f32_16x16x32_bf16 v[40:43], a[16:19], v[68:71], v[40:43]
    v_mfma_f32_16x16x32_bf16 v[40:43], a[32:35], v[72:75], v[40:43]
    buffer_load_dwordx4 v[120:123], v9, s[36:39], s85 offen offset:1024 sc1
    v_mfma_f32_16x16x32_bf16 v[40:43], a[48:51], v[76:79], v[40:43]
    v_mfma_f32_16x16x32_bf16 v[52:55], a[4:7], v[64:67], 0
    v_mfma_f32_16x16x32_bf16 v[52:55], a[20:23], v[68:71], v[52:55]
    buffer_load_dwordx4 v[124:127], v10, s[36:39], s85 offen offset:1024 sc1
    v_mfma_f32_16x16x32_bf16 v[52:55], a[36:39], v[72:75], v[52:55]
    v_mfma_f32_16x16x32_bf16 v[52:55], a[52:55], v[76:79], v[52:55]
    s_waitcnt vmcnt(8)
    v_mfma_f32_16x16x32_bf16 v[180:183], a[72:75], v[80:83], v[180:183]
    v_cmp_gt_u32 vcc, 2, v252
    s_cbranch_vccnz L_p1_slow
L_p1_ok:
    buffer_load_dwordx4 v[128:131], v9, s[36:39], s86 offen offset:0 sc1
    v_mfma_f32_16x16x32_bf16 v[180:183], a[88:91], v[84:87], v[180:183]
    v_mfma_f32_16x16x32_bf16 v[180:183], a[104:107], v[88:91], v[180:183]
    v_mfma_f32_16x16x32_bf16 v[180:183], a[120:123], v[92:95], v[180:183]
    buffer_load_dwordx4 v[132:135], v10, s[36:39], s86 offen offset:0 sc1
    v_mfma_f32_16x16x32_bf16 v[184:187], a[76:79], v[80:83], v[184:187]
    v_mfma_f32_16x16x32_bf16 v[184:187], a[92:95], v[84:87], v[184:187]
    v_mfma_f32_16x16x32_bf16 v[184:187], a[108:111], v[88:91], v[184:187]
    buffer_load_dwordx4 v[136:139], v9, s[36:39], s86 offen offset:1024 sc1
    v_mfma_f32_16x16x32_bf16 v[184:187], a[124:127], v[92:95], v[184:187]
    v_mfma_f32_16x16x32_bf16 v[40:43], a[64:67], v[80:83], v[40:43]
    v_mfma_f32_16x16x32_bf16 v[40:43], a[80:83], v[84:87], v[40:43]
    v_mfma_f32_16x16x32_bf16 v[40:43], a[96:99], v[88:91], v[40:43]
    buffer_load_dwordx4 v[140:143], v10, s[36:39], s86 offen offset:1024 sc1
    v_mfma_f32_16x16x32_bf16 v[40:43], a[112:115], v[92:95], v[40:43]
    v_mfma_f32_16x16x32_bf16 v[52:55], a[68:71], v[80:83], v[52:55]
    v_mfma_f32_16x16x32_bf16 v[52:55], a[84:87], v[84:87], v[52:55]
    buffer_load_dword v253, v13, s[64:67], s5 offen sc1
    v_mfma_f32_16x16x32_bf16 v[52:55], a[100:103], v[88:91], v[52:55]
    v_mfma_f32_16x16x32_bf16 v[52:55], a[116:119], v[92:95], v[52:55]
    s_waitcnt vmcnt(9)
    v_mfma_f32_16x16x32_bf16 v[180:183], a[136:139], v[96:99], v[180:183]
    buffer_load_dwordx4 v[144:147], v9, s[36:39], s87 offen offset:0 sc1
    v_mfma_f32_16x16x32_bf16 v[180:183], a[152:155], v[100:103], v[180:183]
    s_waitcnt lgkmcnt(0)
    v_mfma_f32_16x16x32_bf16 v[180:183], a[168:171], v[104:107], v[180:183]
    v_mfma_f32_16x16x32_bf16 v[180:183], a[184:187], v[108:111], v[180:183]
    buffer_load_dwordx4 v[148:151], v10, s[36:39], s87 offen offset:0 sc1
    v_mfma_f32_16x16x32_bf16 v[184:187], a[140:143], v[96:99], v[184:187]
    v_mfma_f32_16x16x32_bf16 v[184:187], a[156:159], v[100:103], v[184:187]
    v_mfma_f32_16x16x32_bf16 v[184:187], a[172:175], v[104:107], v[184:187]
    buffer_load_dwordx4 v[152:155], v9, s[36:39], s87 offen offset:1024 sc1
    v_mfma_f32_16x16x32_bf16 v[184:187], a[188:191], v[108:111], v[184:187]
    v_mfma_f32_16x16x32_bf16 v[40:43], a[128:131], v[96:99], v[40:43]
    v_mfma_f32_16x16x32_bf16 v[40:43], a[144:147], v[100:103], v[40:43]
    v_mfma_f32_16x16x32_bf16 v[40:43], a[160:163], v[104:107], v[40:43]
    buffer_load_dwordx4 v[156:159], v10, s[36:39], s87 offen offset:1024 sc1
    v_mfma_f32_16x16x32_bf16 v[40:43], a[176:179], v[108:111], v[40:43]
    v_mfma_f32_16x16x32_bf16 v[52:55], a[132:135], v[96:99], v[52:55]
    v_mfma_f32_16x16x32_bf16 v[52:55], a[148:151], v[100:103], v[52:55]
    buffer_load_dwordx4 v[64:67], v9, s[36:39], s88 offen offset:0 sc1
    v_mfma_f32_16x16x32_bf16 v[52:55], a[164:167], v[104:107], v[52:55]
    v_mfma_f32_16x16x32_bf16 v[52:55], a[180:183], v[108:111], v[52:55]
    s_waitcnt vmcnt(10)
    v_mfma_f32_16x16x32_bf16 v[180:183], a[200:203], v[112:115], v[180:183]
    buffer_load_dwordx4 v[68:71], v10, s[36:39], s88 offen offset:0 sc1
    v_mfma_f32_16x16x32_bf16 v[180:183], a[216:219], v[116:119], v[180:183]
    v_mfma_f32_16x16x32_bf16 v[180:183], a[232:235], v[120:123], v[180:183]
    v_mfma_f32_16x16x32_bf16 v[180:183], a[248:251], v[124:127], v[180:183]
    buffer_load_dwordx4 v[72:75], v9, s[36:39], s88 offen offset:1024 sc1
    v_mfma_f32_16x16x32_bf16 v[184:187], a[204:207], v[112:115], v[184:187]
    v_mfma_f32_16x16x32_bf16 v[184:187], a[220:223], v[116:119], v[184:187]
    v_mfma_f32_16x16x32_bf16 v[184:187], a[236:239], v[120:123], v[184:187]
    buffer_load_dwordx4 v[76:79], v10, s[36:39], s88 offen offset:1024 sc1
    v_mfma_f32_16x16x32_bf16 v[184:187], a[252:255], v[124:127], v[184:187]
    v_mfma_f32_16x16x32_bf16 v[40:43], a[192:195], v[112:115], v[40:43]
    v_mfma_f32_16x16x32_bf16 v[40:43], a[208:211], v[116:119], v[40:43]
    v_mfma_f32_16x16x32_bf16 v[40:43], a[224:227], v[120:123], v[40:43]
    buffer_load_dwordx4 v[80:83], v9, s[36:39], s89 offen offset:0 sc1
    v_mfma_f32_16x16x32_bf16 v[40:43], a[240:243], v[124:127], v[40:43]
    ds_write_b128 v172, v[180:183] offset:4096
    v_mfma_f32_16x16x32_bf16 v[52:55], a[196:199], v[112:115], v[52:55]
    v_mfma_f32_16x16x32_bf16 v[52:55], a[212:215], v[116:119], v[52:55]
    buffer_load_dwordx4 v[84:87], v10, s[36:39], s89 offen offset:0 sc1
    v_mfma_f32_16x16x32_bf16 v[52:55], a[228:231], v[120:123], v[52:55]
    ds_write_b128 v172, v[184:187] offset:5120
    v_mfma_f32_16x16x32_bf16 v[52:55], a[244:247], v[124:127], v[52:55]
    s_waitcnt vmcnt(11)
    v_mfma_f32_16x16x32_bf16 v[188:191], a[8:11], v[128:131], 0
    buffer_load_dwordx4 v[88:91], v9, s[36:39], s89 offen offset:1024 sc1
    v_mfma_f32_16x16x32_bf16 v[188:191], a[24:27], v[132:135], v[188:191]
    v_mfma_f32_16x16x32_bf16 v[188:191], a[40:43], v[136:139], v[188:191]
    v_mfma_f32_16x16x32_bf16 v[188:191], a[56:59], v[140:143], v[188:191]
    buffer_load_dwordx4 v[92:95], v10, s[36:39], s89 offen offset:1024 sc1
    s_waitcnt lgkmcnt(0)
    s_barrier
    v_mfma_f32_16x16x32_bf16 v[192:195], a[12:15], v[128:131], 0
    ds_read_b128 v[160:163], v176 offset:4096
    ds_read_b128 v[164:167], v176 offset:5120
    v_mfma_f32_16x16x32_bf16 v[192:195], a[28:31], v[132:135], v[192:195]
    v_mfma_f32_16x16x32_bf16 v[192:195], a[44:47], v[136:139], v[192:195]
    s_waitcnt vmcnt(12)
    v_cmp_gt_u32 vcc, 3, v253
    s_cbranch_vccnz L_p2_slow
L_p2_ok:
    buffer_load_dwordx4 v[96:99], v9, s[36:39], s90 offen offset:0 sc1
    v_mfma_f32_16x16x32_bf16 v[192:195], a[60:63], v[140:143], v[192:195]
    v_mfma_f32_16x16x32_bf16 v[44:47], a[0:3], v[128:131], 0
    v_mfma_f32_16x16x32_bf16 v[44:47], a[16:19], v[132:135], v[44:47]
    v_mfma_f32_16x16x32_bf16 v[44:47], a[32:35], v[136:139], v[44:47]
    buffer_load_dwordx4 v[100:103], v10, s[36:39], s90 offen offset:0 sc1
    v_mfma_f32_16x16x32_bf16 v[44:47], a[48:51], v[140:143], v[44:47]
    s_waitcnt lgkmcnt(1)
    v_add_f32 v40, v40, v160
    v_add_f32 v41, v41, v161
    v_mfma_f32_16x16x32_bf16 v[56:59], a[4:7], v[128:131], 0
    v_add_f32 v42, v42, v162
    v_add_f32 v43, v43, v163
    v_mfma_f32_16x16x32_bf16 v[56:59], a[20:23], v[132:135], v[56:59]
    buffer_load_dwordx4 v[104:107], v9, s[36:39], s90 offen offset:1024 sc1
    s_waitcnt lgkmcnt(0)
    v_add_f32 v52, v52, v164
    v_add_f32 v53, v53, v165
    v_mfma_f32_16x16x32_bf16 v[56:59], a[36:39], v[136:139], v[56:59]
    v_add_f32 v54, v54, v166
    v_add_f32 v55, v55, v167
    v_mfma_f32_16x16x32_bf16 v[56:59], a[52:55], v[140:143], v[56:59]
    s_waitcnt vmcnt(11)
    v_mfma_f32_16x16x32_bf16 v[188:191], a[72:75], v[144:147], v[188:191]
    buffer_load_dwordx4 v[108:111], v10, s[36:39], s90 offen offset:1024 sc1
    v_mfma_f32_16x16x32_bf16 v[188:191], a[88:91], v[148:151], v[188:191]
    v_mfma_f32_16x16x32_bf16 v[188:191], a[104:107], v[152:155], v[188:191]
    v_mfma_f32_16x16x32_bf16 v[188:191], a[120:123], v[156:159], v[188:191]
    v_mfma_f32_16x16x32_bf16 v[192:195], a[76:79], v[144:147], v[192:195]
    buffer_load_dwordx4 v[112:115], v9, s[36:39], s91 offen offset:0 sc1
    v_mfma_f32_16x16x32_bf16 v[192:195], a[92:95], v[148:151], v[192:195]
    v_mfma_f32_16x16x32_bf16 v[192:195], a[108:111], v[152:155], v[192:195]
    v_mfma_f32_16x16x32_bf16 v[192:195], a[124:127], v[156:159], v[192:195]
    v_mfma_f32_16x16x32_bf16 v[44:47], a[64:67], v[144:147], v[44:47]
    buffer_load_dwordx4 v[116:119], v10, s[36:39], s91 offen offset:0 sc1
    v_mfma_f32_16x16x32_bf16 v[44:47], a[80:83], v[148:151], v[44:47]
    v_mfma_f32_16x16x32_bf16 v[44:47], a[96:99], v[152:155], v[44:47]
    v_mfma_f32_16x16x32_bf16 v[44:47], a[112:115], v[156:159], v[44:47]
    v_mfma_f32_16x16x32_bf16 v[56:59], a[68:71], v[144:147], v[56:59]
    buffer_load_dwordx4 v[120:123], v9, s[36:39], s91 offen offset:1024 sc1
    v_mfma_f32_16x16x32_bf16 v[56:59], a[84:87], v[148:151], v[56:59]
    v_mfma_f32_16x16x32_bf16 v[56:59], a[100:103], v[152:155], v[56:59]
    v_mfma_f32_16x16x32_bf16 v[56:59], a[116:119], v[156:159], v[56:59]
    s_waitcnt vmcnt(11)
    v_mfma_f32_16x16x32_bf16 v[188:191], a[136:139], v[64:67], v[188:191]
    buffer_load_dwordx4 v[124:127], v10, s[36:39], s91 offen offset:1024 sc1
    v_mfma_f32_16x16x32_bf16 v[188:191], a[152:155], v[68:71], v[188:191]
    v_mfma_f32_16x16x32_bf16 v[188:191], a[168:171], v[72:75], v[188:191]
    v_mfma_f32_16x16x32_bf16 v[188:191], a[184:187], v[76:79], v[188:191]
    v_mfma_f32_16x16x32_bf16 v[192:195], a[140:143], v[64:67], v[192:195]
    buffer_load_dwordx4 v[128:131], v9, s[36:39], s92 offen offset:0 sc1
    v_mfma_f32_16x16x32_bf16 v[192:195], a[156:159], v[68:71], v[192:195]
    v_mfma_f32_16x16x32_bf16 v[192:195], a[172:175], v[72:75], v[192:195]
    v_mfma_f32_16x16x32_bf16 v[192:195], a[188:191], v[76:79], v[192:195]
    v_mfma_f32_16x16x32_bf16 v[44:47], a[128:131], v[64:67], v[44:47]
    buffer_load_dwordx4 v[132:135], v10, s[36:39], s92 offen offset:0 sc1
    v_mfma_f32_16x16x32_bf16 v[44:47], a[144:147], v[68:71], v[44:47]
    v_mfma_f32_16x16x32_bf16 v[44:47], a[160:163], v[72:75], v[44:47]
    v_mfma_f32_16x16x32_bf16 v[44:47], a[176:179], v[76:79], v[44:47]
    v_mfma_f32_16x16x32_bf16 v[56:59], a[132:135], v[64:67], v[56:59]
    buffer_load_dwordx4 v[136:139], v9, s[36:39], s92 offen offset:1024 sc1
    v_mfma_f32_16x16x32_bf16 v[56:59], a[148:151], v[68:71], v[56:59]
    v_mfma_f32_16x16x32_bf16 v[56:59], a[164:167], v[72:75], v[56:59]
    v_mfma_f32_16x16x32_bf16 v[56:59], a[180:183], v[76:79], v[56:59]
    s_waitcnt vmcnt(11)
    v_mfma_f32_16x16x32_bf16 v[188:191], a[200:203], v[80:83], v[188:191]
    buffer_load_dwordx4 v[140:143], v10, s[36:39], s92 offen offset:1024 sc1
    v_mfma_f32_16x16x32_bf16 v[188:191], a[216:219], v[84:87], v[188:191]
    v_mfma_f32_16x16x32_bf16 v[188:191], a[232:235], v[88:91], v[188:191]
    v_mfma_f32_16x16x32_bf16 v[188:191], a[248:251], v[92:95], v[188:191]
    v_mfma_f32_16x16x32_bf16 v[192:195], a[204:207], v[80:83], v[192:195]
    buffer_load_dwordx4 v[144:147], v9, s[36:39], s93 offen offset:0 sc1
    v_mfma_f32_16x16x32_bf16 v[192:195], a[220:223], v[84:87], v[192:195]
    v_mfma_f32_16x16x32_bf16 v[192:195], a[236:239], v[88:91], v[192:195]
    v_mfma_f32_16x16x32_bf16 v[192:195], a[252:255], v[92:95], v[192:195]
    v_mfma_f32_16x16x32_bf16 v[44:47], a[192:195], v[80:83], v[44:47]
    buffer_load_dwordx4 v[148:151], v10, s[36:39], s93 offen offset:0 sc1
    v_mfma_f32_16x16x32_bf16 v[44:47], a[208:211], v[84:87], v[44:47]
    v_mfma_f32_16x16x32_bf16 v[44:47], a[224:227], v[88:91], v[44:47]
    v_mfma_f32_16x16x32_bf16 v[44:47], a[240:243], v[92:95], v[44:47]
    ds_write_b128 v172, v[188:191] offset:6144
    v_mfma_f32_16x16x32_bf16 v[56:59], a[196:199], v[80:83], v[56:59]
    buffer_load_dwordx4 v[152:155], v9, s[36:39], s93 offen offset:1024 sc1
    v_mfma_f32_16x16x32_bf16 v[56:59], a[212:215], v[84:87], v[56:59]
    v_mfma_f32_16x16x32_bf16 v[56:59], a[228:231], v[88:91], v[56:59]
    ds_write_b128 v172, v[192:195] offset:7168
    v_mfma_f32_16x16x32_bf16 v[56:59], a[244:247], v[92:95], v[56:59]
    s_waitcnt vmcnt(11)
    v_mfma_f32_16x16x32_bf16 v[180:183], a[8:11], v[96:99], 0
    buffer_load_dwordx4 v[156:159], v10, s[36:39], s93 offen offset:1024 sc1
    v_mfma_f32_16x16x32_bf16 v[180:183], a[24:27], v[100:103], v[180:183]
    v_mfma_f32_16x16x32_bf16 v[180:183], a[40:43], v[104:107], v[180:183]
    v_mfma_f32_16x16x32_bf16 v[180:183], a[56:59], v[108:111], v[180:183]
    s_waitcnt lgkmcnt(0)
    s_barrier
    v_mfma_f32_16x16x32_bf16 v[184:187], a[12:15], v[96:99], 0
    ds_read_b128 v[160:163], v176 offset:6144
    ds_read_b128 v[164:167], v176 offset:7168
    v_mfma_f32_16x16x32_bf16 v[184:187], a[28:31], v[100:103], v[184:187]
    v_mfma_f32_16x16x32_bf16 v[184:187], a[44:47], v[104:107], v[184:187]
    v_mfma_f32_16x16x32_bf16 v[184:187], a[60:63], v[108:111], v[184:187]
    v_mfma_f32_16x16x32_bf16 v[48:51], a[0:3], v[96:99], 0
    v_mfma_f32_16x16x32_bf16 v[48:51], a[16:19], v[100:103], v[48:51]
    v_mfma_f32_16x16x32_bf16 v[48:51], a[32:35], v[104:107], v[48:51]
    v_cvt_pk_bf16_f32 v208, v40, v41
    v_cvt_pk_bf16_f32 v209, v42, v43
    v_mfma_f32_16x16x32_bf16 v[48:51], a[48:51], v[108:111], v[48:51]
    s_waitcnt lgkmcnt(1)
    v_add_f32 v44, v44, v160
    v_add_f32 v45, v45, v161
    v_mfma_f32_16x16x32_bf16 v[60:63], a[4:7], v[96:99], 0
    v_add_f32 v46, v46, v162
    v_add_f32 v47, v47, v163
    v_mfma_f32_16x16x32_bf16 v[60:63], a[20:23], v[100:103], v[60:63]
    v_cvt_pk_bf16_f32 v210, v52, v53
    v_cvt_pk_bf16_f32 v211, v54, v55
    buffer_store_dwordx4 v[208:211], v199, s[64:67], s8 offen offset:0 sc1
    s_waitcnt lgkmcnt(0)
    v_add_f32 v56, v56, v164
    v_add_f32 v57, v57, v165
    v_mfma_f32_16x16x32_bf16 v[60:63], a[36:39], v[104:107], v[60:63]
    v_add_f32 v58, v58, v166
    v_add_f32 v59, v59, v167
    v_mfma_f32_16x16x32_bf16 v[60:63], a[52:55], v[108:111], v[60:63]
    s_waitcnt vmcnt(9)
    v_mfma_f32_16x16x32_bf16 v[180:183], a[72:75], v[112:115], v[180:183]
    v_mfma_f32_16x16x32_bf16 v[180:183], a[88:91], v[116:119], v[180:183]
    v_cvt_pk_bf16_f32 v212, v44, v45
    v_cvt_pk_bf16_f32 v213, v46, v47
    v_mfma_f32_16x16x32_bf16 v[180:183], a[104:107], v[120:123], v[180:183]
    v_mfma_f32_16x16x32_bf16 v[180:183], a[120:123], v[124:127], v[180:183]
    v_mfma_f32_16x16x32_bf16 v[184:187], a[76:79], v[112:115], v[184:187]
    v_cvt_pk_bf16_f32 v214, v56, v57
    v_cvt_pk_bf16_f32 v215, v58, v59
    buffer_store_dwordx4 v[212:215], v199, s[64:67], s8 offen offset:1024 sc1
    v_mfma_f32_16x16x32_bf16 v[184:187], a[92:95], v[116:119], v[184:187]
    v_mfma_f32_16x16x32_bf16 v[184:187], a[108:111], v[120:123], v[184:187]
    v_mfma_f32_16x16x32_bf16 v[184:187], a[124:127], v[124:127], v[184:187]
    v_mfma_f32_16x16x32_bf16 v[48:51], a[64:67], v[112:115], v[48:51]
    v_mfma_f32_16x16x32_bf16 v[48:51], a[80:83], v[116:119], v[48:51]
    v_mfma_f32_16x16x32_bf16 v[48:51], a[96:99], v[120:123], v[48:51]
    v_mfma_f32_16x16x32_bf16 v[48:51], a[112:115], v[124:127], v[48:51]
    v_mfma_f32_16x16x32_bf16 v[60:63], a[68:71], v[112:115], v[60:63]
    v_mfma_f32_16x16x32_bf16 v[60:63], a[84:87], v[116:119], v[60:63]
    v_mfma_f32_16x16x32_bf16 v[60:63], a[100:103], v[120:123], v[60:63]
    v_mfma_f32_16x16x32_bf16 v[60:63], a[116:119], v[124:127], v[60:63]
    s_waitcnt vmcnt(6)
    v_mfma_f32_16x16x32_bf16 v[180:183], a[136:139], v[128:131], v[180:183]
    v_mfma_f32_16x16x32_bf16 v[180:183], a[152:155], v[132:135], v[180:183]
    v_mfma_f32_16x16x32_bf16 v[180:183], a[168:171], v[136:139], v[180:183]
    v_mfma_f32_16x16x32_bf16 v[180:183], a[184:187], v[140:143], v[180:183]
    v_mfma_f32_16x16x32_bf16 v[184:187], a[140:143], v[128:131], v[184:187]
    v_mfma_f32_16x16x32_bf16 v[184:187], a[156:159], v[132:135], v[184:187]
    v_mfma_f32_16x16x32_bf16 v[184:187], a[172:175], v[136:139], v[184:187]
    v_mfma_f32_16x16x32_bf16 v[184:187], a[188:191], v[140:143], v[184:187]
    s_waitcnt vmcnt(2)
    v_mfma_f32_16x16x32_bf16 v[180:183], a[200:203], v[144:147], v[180:183]
    v_mfma_f32_16x16x32_bf16 v[180:183], a[216:219], v[148:151], v[180:183]
    v_mfma_f32_16x16x32_bf16 v[180:183], a[232:235], v[152:155], v[180:183]
    v_mfma_f32_16x16x32_bf16 v[180:183], a[248:251], v[156:159], v[180:183]
    v_mfma_f32_16x16x32_bf16 v[184:187], a[204:207], v[144:147], v[184:187]
    v_mfma_f32_16x16x32_bf16 v[184:187], a[220:223], v[148:151], v[184:187]
    v_mfma_f32_16x16x32_bf16 v[184:187], a[236:239], v[152:155], v[184:187]
    v_mfma_f32_16x16x32_bf16 v[184:187], a[252:255], v[156:159], v[184:187]
    v_mfma_f32_16x16x32_bf16 v[48:51], a[128:131], v[128:131], v[48:51]
    v_mfma_f32_16x16x32_bf16 v[48:51], a[144:147], v[132:135], v[48:51]
    v_mfma_f32_16x16x32_bf16 v[48:51], a[160:163], v[136:139], v[48:51]
    v_mfma_f32_16x16x32_bf16 v[48:51], a[176:179], v[140:143], v[48:51]
    ds_write_b128 v172, v[180:183] offset:16384
    v_mfma_f32_16x16x32_bf16 v[60:63], a[132:135], v[128:131], v[60:63]
    v_mfma_f32_16x16x32_bf16 v[60:63], a[148:151], v[132:135], v[60:63]
    s_waitcnt vmcnt(0)
    buffer_store_dword v197, v15, s[64:67], s7 offen sc1
    v_mfma_f32_16x16x32_bf16 v[60:63], a[164:167], v[136:139], v[60:63]
    ds_write_b128 v172, v[184:187] offset:17408
    v_mfma_f32_16x16x32_bf16 v[60:63], a[180:183], v[140:143], v[60:63]
    v_mfma_f32_16x16x32_bf16 v[48:51], a[192:195], v[144:147], v[48:51]
    v_mfma_f32_16x16x32_bf16 v[48:51], a[208:211], v[148:151], v[48:51]
    buffer_load_dword v250, v5, s[64:67], s15 offen sc1
    v_mfma_f32_16x16x32_bf16 v[48:51], a[224:227], v[152:155], v[48:51]
    v_mfma_f32_16x16x32_bf16 v[48:51], a[240:243], v[156:159], v[48:51]
    s_waitcnt lgkmcnt(0)
    s_barrier
    s_cmp_lg_u32 s41, 0
    s_cbranch_scc1 L_clf
    buffer_store_dword v6, v8, s[64:67], s6 offen sc1
L_clf:
    v_mfma_f32_16x16x32_bf16 v[60:63], a[196:199], v[144:147], v[60:63]
    ds_read_b128 v[160:163], v176 offset:16384
    ds_read_b128 v[164:167], v176 offset:17408
    v_mfma_f32_16x16x32_bf16 v[60:63], a[212:215], v[148:151], v[60:63]
    v_mfma_f32_16x16x32_bf16 v[60:63], a[228:231], v[152:155], v[60:63]
    v_mfma_f32_16x16x32_bf16 v[60:63], a[244:247], v[156:159], v[60:63]
    s_waitcnt lgkmcnt(1)
    v_pk_add_f32 v[48:49], v[48:49], v[160:161]
    v_pk_add_f32 v[50:51], v[50:51], v[162:163]
    s_waitcnt lgkmcnt(0)
    s_nop 3
    v_pk_add_f32 v[60:61], v[60:61], v[164:165]
    v_pk_add_f32 v[62:63], v[62:63], v[166:167]
    v_cvt_pk_bf16_f32 v216, v48, v49
    v_cvt_pk_bf16_f32 v217, v50, v51
    v_cvt_pk_bf16_f32 v218, v60, v61
    v_cvt_pk_bf16_f32 v219, v62, v63
    buffer_store_dwordx4 v[216:219], v199, s[64:67], s8 offen offset:2048 sc1
    s_cmp_lg_u32 s42, s48
    s_cbranch_scc1 L_end
    s_waitcnt vmcnt(1)
    v_cmp_eq_u32 vcc, 0, v250
    s_cbranch_vccnz L_f3_slow
L_f3_ok:
    buffer_load_dwordx4 v[64:67], v36, s[64:67], s76 offen offset:0 sc1
    buffer_load_dwordx4 v[68:71], v36, s[64:67], s78 offen offset:0 sc1
    buffer_load_dwordx4 v[72:75], v36, s[64:67], s80 offen offset:0 sc1
    buffer_load_dwordx4 v[88:91], v36, s[64:67], s76 offen offset:1024 sc1
    buffer_load_dwordx4 v[92:95], v36, s[64:67], s78 offen offset:1024 sc1
    buffer_load_dwordx4 v[96:99], v36, s[64:67], s80 offen offset:1024 sc1
    buffer_load_dwordx4 v[112:115], v36, s[64:67], s76 offen offset:2048 sc1
    buffer_load_dwordx4 v[116:119], v36, s[64:67], s78 offen offset:2048 sc1
    buffer_load_dwordx4 v[120:123], v36, s[64:67], s80 offen offset:2048 sc1
    s_waitcnt vmcnt(8)
    v_lshlrev_b32 v76, 16, v64
    v_and_b32 v77, 0xffff0000, v64
    v_lshlrev_b32 v78, 16, v65
    v_and_b32 v79, 0xffff0000, v65
    v_lshlrev_b32 v80, 16, v66
    v_and_b32 v81, 0xffff0000, v66
    v_lshlrev_b32 v82, 16, v67
    v_and_b32 v83, 0xffff0000, v67
    v_pk_add_f32 v[40:41], v[40:41], v[76:77]
    v_pk_add_f32 v[42:43], v[42:43], v[78:79]
    v_pk_add_f32 v[52:53], v[52:53], v[80:81]
    v_pk_add_f32 v[54:55], v[54:55], v[82:83]
    s_waitcnt vmcnt(7)
    v_lshlrev_b32 v76, 16, v68
    v_and_b32 v77, 0xffff0000, v68
    v_lshlrev_b32 v78, 16, v69
    v_and_b32 v79, 0xffff0000, v69
    v_lshlrev_b32 v80, 16, v70
    v_and_b32 v81, 0xffff0000, v70
    v_lshlrev_b32 v82, 16, v71
    v_and_b32 v83, 0xffff0000, v71
    v_pk_add_f32 v[40:41], v[40:41], v[76:77]
    v_pk_add_f32 v[42:43], v[42:43], v[78:79]
    v_pk_add_f32 v[52:53], v[52:53], v[80:81]
    v_pk_add_f32 v[54:55], v[54:55], v[82:83]
    s_waitcnt vmcnt(6)
    v_lshlrev_b32 v76, 16, v72
    v_and_b32 v77, 0xffff0000, v72
    v_lshlrev_b32 v78, 16, v73
    v_and_b32 v79, 0xffff0000, v73
    v_lshlrev_b32 v80, 16, v74
    v_and_b32 v81, 0xffff0000, v74
    v_lshlrev_b32 v82, 16, v75
    v_and_b32 v83, 0xffff0000, v75
    v_pk_add_f32 v[40:41], v[40:41], v[76:77]
    v_pk_add_f32 v[42:43], v[42:43], v[78:79]
    v_pk_add_f32 v[52:53], v[52:53], v[80:81]
    v_pk_add_f32 v[54:55], v[54:55], v[82:83]
    v_cvt_pk_bf16_f32 v140, v40, v41
    v_cvt_pk_bf16_f32 v141, v42, v43
    v_cvt_pk_bf16_f32 v142, v52, v53
    v_cvt_pk_bf16_f32 v143, v54, v55
    s_nop 0
    v_permlane16_swap_b32 v140, v142
    v_permlane16_swap_b32 v141, v143
    buffer_store_dwordx4 v[140:143], v11, s[72:75], s12 offen sc1
    s_waitcnt vmcnt(6)
    v_lshlrev_b32 v100, 16, v88
    v_and_b32 v101, 0xffff0000, v88
    v_lshlrev_b32 v102, 16, v89
    v_and_b32 v103, 0xffff0000, v89
    v_lshlrev_b32 v104, 16, v90
    v_and_b32 v105, 0xffff0000, v90
    v_lshlrev_b32 v106, 16, v91
    v_and_b32 v107, 0xffff0000, v91
    v_pk_add_f32 v[44:45], v[44:45], v[100:101]
    v_pk_add_f32 v[46:47], v[46:47], v[102:103]
    v_pk_add_f32 v[56:57], v[56:57], v[104:105]
    v_pk_add_f32 v[58:59], v[58:59], v[106:107]
    s_waitcnt vmcnt(5)
    v_lshlrev_b32 v100, 16, v92
    v_and_b32 v101, 0xffff0000, v92
    v_lshlrev_b32 v102, 16, v93
    v_and_b32 v103, 0xffff0000, v93
    v_lshlrev_b32 v104, 16, v94
    v_and_b32 v105, 0xffff0000, v94
    v_lshlrev_b32 v106, 16, v95
    v_and_b32 v107, 0xffff0000, v95
    v_pk_add_f32 v[44:45], v[44:45], v[100:101]
    v_pk_add_f32 v[46:47], v[46:47], v[102:103]
    v_pk_add_f32 v[56:57], v[56:57], v[104:105]
    v_pk_add_f32 v[58:59], v[58:59], v[106:107]
    s_waitcnt vmcnt(4)
    v_lshlrev_b32 v100, 16, v96
    v_and_b32 v101, 0xffff0000, v96
    v_lshlrev_b32 v102, 16, v97
    v_and_b32 v103, 0xffff0000, v97
    v_lshlrev_b32 v104, 16, v98
    v_and_b32 v105, 0xffff0000, v98
    v_lshlrev_b32 v106, 16, v99
    v_and_b32 v107, 0xffff0000, v99
    v_pk_add_f32 v[44:45], v[44:45], v[100:101]
    v_pk_add_f32 v[46:47], v[46:47], v[102:103]
    v_pk_add_f32 v[56:57], v[56:57], v[104:105]
    v_pk_add_f32 v[58:59], v[58:59], v[106:107]
    v_cvt_pk_bf16_f32 v144, v44, v45
    v_cvt_pk_bf16_f32 v145, v46, v47
    v_cvt_pk_bf16_f32 v146, v56, v57
    v_cvt_pk_bf16_f32 v147, v58, v59
    s_nop 0
    v_permlane16_swap_b32 v144, v146
    v_permlane16_swap_b32 v145, v147
    buffer_store_dwordx4 v[144:147], v11, s[72:75], s13 offen sc1
    s_waitcnt vmcnt(4)
    v_max_u32 v12, v112, v113
    v_max3_u32 v12, v12, v114, v115
    s_waitcnt vmcnt(3)
    v_max3_u32 v12, v12, v116, v117
    v_max3_u32 v12, v12, v118, v119
    s_waitcnt vmcnt(2)
    v_max3_u32 v12, v12, v120, v121
    v_max3_u32 v12, v12, v122, v123
    v_cmp_eq_u32 vcc, -1, v12
    s_cbranch_vccnz L_d2_slow
L_d2_ok:
    v_lshlrev_b32 v124, 16, v112
    v_and_b32 v125, 0xffff0000, v112
    v_lshlrev_b32 v126, 16, v113
    v_and_b32 v127, 0xffff0000, v113
    v_lshlrev_b32 v128, 16, v114
    v_and_b32 v129, 0xffff0000, v114
    v_lshlrev_b32 v130, 16, v115
    v_and_b32 v131, 0xffff0000, v115
    v_pk_add_f32 v[48:49], v[48:49], v[124:125]
    v_pk_add_f32 v[50:51], v[50:51], v[126:127]
    v_pk_add_f32 v[60:61], v[60:61], v[128:129]
    v_pk_add_f32 v[62:63], v[62:63], v[130:131]
    v_lshlrev_b32 v124, 16, v116
    v_and_b32 v125, 0xffff0000, v116
    v_lshlrev_b32 v126, 16, v117
    v_and_b32 v127, 0xffff0000, v117
    v_lshlrev_b32 v128, 16, v118
    v_and_b32 v129, 0xffff0000, v118
    v_lshlrev_b32 v130, 16, v119
    v_and_b32 v131, 0xffff0000, v119
    v_pk_add_f32 v[48:49], v[48:49], v[124:125]
    v_pk_add_f32 v[50:51], v[50:51], v[126:127]
    v_pk_add_f32 v[60:61], v[60:61], v[128:129]
    v_pk_add_f32 v[62:63], v[62:63], v[130:131]
    v_lshlrev_b32 v124, 16, v120
    v_and_b32 v125, 0xffff0000, v120
    v_lshlrev_b32 v126, 16, v121
    v_and_b32 v127, 0xffff0000, v121
    v_lshlrev_b32 v128, 16, v122
    v_and_b32 v129, 0xffff0000, v122
    v_lshlrev_b32 v130, 16, v123
    v_and_b32 v131, 0xffff0000, v123
    v_pk_add_f32 v[48:49], v[48:49], v[124:125]
    v_pk_add_f32 v[50:51], v[50:51], v[126:127]
    v_pk_add_f32 v[60:61], v[60:61], v[128:129]
    v_pk_add_f32 v[62:63], v[62:63], v[130:131]
    v_cvt_pk_bf16_f32 v148, v48, v49
    v_cvt_pk_bf16_f32 v149, v50, v51
    v_cvt_pk_bf16_f32 v150, v60, v61
    v_cvt_pk_bf16_f32 v151, v62, v63
    s_nop 0
    v_permlane16_swap_b32 v148, v150
    v_permlane16_swap_b32 v149, v151
    buffer_store_dwordx4 v[148:151], v11, s[72:75], s14 offen sc1
L_end:
    s_endpgm
L_fb:
    s_waitcnt vmcnt(0) lgkmcnt(0)
    s_barrier
    s_mov_b32 s53, 1
    s_mov_b32 m0, s43
    s_mov_b32 s44, 0
L_fb_loop:
    buffer_load_dwordx4 v17, s[28:31], s44 offen offset:0 lds
    buffer_load_dwordx4 v18, s[28:31], s44 offen offset:1024 lds
    buffer_load_dwordx4 v19, s[28:31], s44 offen offset:2048 lds
    buffer_load_dwordx4 v20, s[28:31], s44 offen offset:3072 lds
    s_waitcnt vmcnt(0)
    ds_read_b128 a[136:139], v31
    ds_read_b128 a[140:143], v32
    ds_read_b128 a[144:147], v33
    ds_read_b128 a[148:151], v34
    s_waitcnt lgkmcnt(0)
    v_mfma_f32_16x16x32_bf16 v[64:67], a[136:139], a[0:3], 0
    v_mfma_f32_16x16x32_bf16 v[64:67], a[140:143], a[12:15], v[64:67]
    v_mfma_f32_16x16x32_bf16 v[64:67], a[144:147], a[24:27], v[64:67]
    v_mfma_f32_16x16x32_bf16 v[64:67], a[148:151], a[36:39], v[64:67]
    v_mfma_f32_16x16x32_bf16 v[68:71], a[136:139], a[4:7], 0
    v_mfma_f32_16x16x32_bf16 v[68:71], a[140:143], a[16:19], v[68:71]
    v_mfma_f32_16x16x32_bf16 v[68:71], a[144:147], a[28:31], v[68:71]
    v_mfma_f32_16x16x32_bf16 v[68:71], a[148:151], a[40:43], v[68:71]
    v_mfma_f32_16x16x32_bf16 v[72:75], a[136:139], a[8:11], 0
    v_mfma_f32_16x16x32_bf16 v[72:75], a[140:143], a[20:23], v[72:75]
    v_mfma_f32_16x16x32_bf16 v[72:75], a[144:147], a[32:35], v[72:75]
    v_mfma_f32_16x16x32_bf16 v[72:75], a[148:151], a[44:47], v[72:75]
    s_nop 7
    v_max3_f32 v220, v220, v64, v65
    v_max3_f32 v220, v220, v66, v67
    v_max3_f32 v221, v221, v68, v69
    v_max3_f32 v221, v221, v70, v71
    v_max3_f32 v222, v222, v72, v73
    v_max3_f32 v222, v222, v74, v75
    s_add_u32 s45, s44, 28672
    s_add_u32 s44, s44, 4096
    s_bitcmp1_b32 s44, 12
    s_cselect_b32 s44, s44, s45
    s_cmp_lt_u32 s44, 0x40000
    s_cbranch_scc1 L_fb_loop
    s_add_u32 m0, s43, 0
    s_nop 0
    buffer_load_dwordx4 v17, s[28:31], s76 offen offset:0 lds
    buffer_load_dwordx4 v18, s[28:31], s76 offen offset:1024 lds
    buffer_load_dwordx4 v19, s[28:31], s76 offen offset:2048 lds
    buffer_load_dwordx4 v20, s[28:31], s76 offen offset:3072 lds
    s_add_u32 m0, s43, 28672
    s_nop 0
    buffer_load_dwordx4 v17, s[28:31], s77 offen offset:0 lds
    buffer_load_dwordx4 v18, s[28:31], s77 offen offset:1024 lds
    buffer_load_dwordx4 v19, s[28:31], s77 offen offset:2048 lds
    buffer_load_dwordx4 v20, s[28:31], s77 offen offset:3072 lds
    s_add_u32 m0, s43, 32768
    s_nop 0
    buffer_load_dwordx4 v17, s[28:31], s78 offen offset:0 lds
    buffer_load_dwordx4 v18, s[28:31], s78 offen offset:1024 lds
    buffer_load_dwordx4 v19, s[28:31], s78 offen offset:2048 lds
    buffer_load_dwordx4 v20, s[28:31], s78 offen offset:3072 lds
    s_add_u32 m0, s43, 12288
    s_nop 0
    buffer_load_dwordx4 v17, s[28:31], s79 offen offset:0 lds
    buffer_load_dwordx4 v18, s[28:31], s79 offen offset:1024 lds
    buffer_load_dwordx4 v19, s[28:31], s79 offen offset:2048 lds
    buffer_load_dwordx4 v20, s[28:31], s79 offen offset:3072 lds
    s_add_u32 m0, s43, 8192
    s_nop 0
    buffer_load_dwordx4 v17, s[28:31], s80 offen offset:0 lds
    buffer_load_dwordx4 v18, s[28:31], s80 offen offset:1024 lds
    buffer_load_dwordx4 v19, s[28:31], s80 offen offset:2048 lds
    buffer_load_dwordx4 v20, s[28:31], s80 offen offset:3072 lds
    s_add_u32 m0, s43, 24576
    s_nop 0
    buffer_load_dwordx4 v17, s[28:31], s81 offen offset:0 lds
    buffer_load_dwordx4 v18, s[28:31], s81 offen offset:1024 lds
    buffer_load_dwordx4 v19, s[28:31], s81 offen offset:2048 lds
    buffer_load_dwordx4 v20, s[28:31], s81 offen offset:3072 lds
    s_add_u32 m0, s43, 16384
    s_nop 0
    buffer_load_dwordx4 v17, s[28:31], s82 offen offset:0 lds
    buffer_load_dwordx4 v18, s[28:31], s82 offen offset:1024 lds
    s_waitcnt vmcnt(0)
    ds_read_b128 a[136:139], v31 offset:0
    ds_read_b128 a[140:143], v32 offset:0
    ds_read_b128 a[144:147], v33 offset:0
    ds_read_b128 a[148:151], v34 offset:0
    s_waitcnt lgkmcnt(0)
    s_branch L_att
L_arr_slow:
    s_mov_b32 s44, 100000
L_arr_spin:
    s_sub_u32 s44, s44, 1
    s_cmp_eq_u32 s44, 0
    s_cbranch_scc1 L_arr_ok
    buffer_load_dword v250, v1, s[68:71], 0 offen sc1
    s_waitcnt vmcnt(0)
    v_cmp_eq_u32 vcc, 0, v250
    s_cbranch_vccnz L_arr_spin
    s_branch L_arr_ok
L_chk:
    s_cmp_eq_u32 s53, 0
    s_cbranch_scc1 L_fb
    s_branch L_chk_ok
L_fl0_far:
    buffer_store_dword v6, v8, s[64:67], s6 offen sc1
    s_branch L_fl0_done
L_fl1_far:
    buffer_store_dword v6, v8, s[64:67], s6 offen sc1
    s_branch L_fl1_done
L_fl2_far:
    buffer_store_dword v6, v8, s[64:67], s6 offen sc1
    s_branch L_fl2_done
L_p0_slow:
    s_mov_b32 s44, 100000
L_p0_spin:
    s_sub_u32 s44, s44, 1
    s_cmp_eq_u32 s44, 0
    s_cbranch_scc1 L_p0_ok
    buffer_load_dword v251, v13, s[64:67], s5 offen sc1
    s_waitcnt vmcnt(0)
    v_cmp_gt_u32 vcc, 1, v251
    s_cbranch_vccnz L_p0_spin
    s_branch L_p0_ok
L_p1_slow:
    s_mov_b32 s44, 100000
L_p1_spin:
    s_sub_u32 s44, s44, 1
    s_cmp_eq_u32 s44, 0
    s_cbranch_scc1 L_p1_ok
    buffer_load_dword v252, v13, s[64:67], s5 offen sc1
    s_waitcnt vmcnt(0)
    v_cmp_gt_u32 vcc, 2, v252
    s_cbranch_vccnz L_p1_spin
    s_branch L_p1_ok
L_p2_slow:
    s_mov_b32 s44, 100000
L_p2_spin:
    s_sub_u32 s44, s44, 1
    s_cmp_eq_u32 s44, 0
    s_cbranch_scc1 L_p2_ok
    buffer_load_dword v253, v13, s[64:67], s5 offen sc1
    s_waitcnt vmcnt(0)
    v_cmp_gt_u32 vcc, 3, v253
    s_cbranch_vccnz L_p2_spin
    s_branch L_p2_ok
L_f3_slow:
    s_mov_b32 s44, 100000
L_f3_spin:
    s_sub_u32 s44, s44, 1
    s_cmp_eq_u32 s44, 0
    s_cbranch_scc1 L_f3_ok
    buffer_load_dword v250, v5, s[64:67], s15 offen sc1
    s_waitcnt vmcnt(0)
    v_cmp_eq_u32 vcc, 0, v250
    s_cbranch_vccnz L_f3_spin
    s_branch L_f3_ok
L_d2_slow:
    s_mov_b32 s44, 100000
L_d2_spin:
    s_sub_u32 s44, s44, 1
    s_cmp_eq_u32 s44, 0
    s_cbranch_scc1 L_d2_ok
    buffer_load_dwordx4 v[112:115], v36, s[64:67], s76 offen offset:2048 sc1
    buffer_load_dwordx4 v[116:119], v36, s[64:67], s78 offen offset:2048 sc1
    buffer_load_dwordx4 v[120:123], v36, s[64:67], s80 offen offset:2048 sc1
    s_waitcnt vmcnt(0)
    v_max_u32 v12, v112, v113
    v_max3_u32 v12, v12, v114, v115
    v_max3_u32 v12, v12, v116, v117
    v_max3_u32 v12, v12, v118, v119
    v_max3_u32 v12, v12, v120, v121
    v_max3_u32 v12, v12, v122, v123
    v_cmp_eq_u32 vcc, -1, v12
    s_cbranch_vccnz L_d2_spin
    s_branch L_d2_ok
L_codeend:
    s_endpgm
.section .rodata,"a"
.p2align 6
.amdhsa_kernel standalone__gqa_block_cached__near_ridge_kernel
  .amdhsa_next_free_vgpr 512
  .amdhsa_next_free_sgpr 102
  .amdhsa_accum_offset 256
  .amdhsa_group_segment_fixed_size 0
  .amdhsa_kernarg_size 64
  .amdhsa_user_sgpr_count 2
  .amdhsa_user_sgpr_kernarg_segment_ptr 1
  .amdhsa_system_sgpr_workgroup_id_x 1
  .amdhsa_float_denorm_mode_32 3
.end_amdhsa_kernel
```
